```python
import torch

def _softmax(x, axis=-1):
    return torch.softmax(x, dim=axis)
def _gelu(x):
    return torch.nn.functional.gelu(x, approximate="tanh")
def _silu(x):
    return torch.nn.functional.silu(x)
def _sigmoid(x):
    return torch.sigmoid(x)
def _layernorm(x, axis=-1, eps=1e-5):
    m = x.mean(dim=axis, keepdim=True)
    v = x.var(dim=axis, keepdim=True, unbiased=False)
    return (x - m) / torch.sqrt(v + eps)
def _scatter_add(tgt, idx, src, axis=0):
    return tgt.clone().index_add_(axis, idx, src)
def _segment_sum(src, seg, n):
    out = torch.zeros((n,) + src.shape[1:], dtype=src.dtype)
    return out.index_add_(0, seg, src)
def _pad(x, pw):
    flat = tuple(v for pair in reversed(pw) for v in pair)
    return torch.nn.functional.pad(x, flat)

kernel_name = 'sequential_preLN__linear_kernel_hedgehog__dense_activation_squared_relu__prompt'

def setup_inputs():

    _w = (lambda a: (lambda t: t.to(torch.bfloat16) if t.is_floating_point() else t)(torch.as_tensor(a)))
    def _A_setup():
        B, S, D, H = 1, 2048, 640, 32
        Dh = D // H
        return {
            "x": _w((lambda *s: torch.randn(*s, dtype=torch.bfloat16) * 0.05)(B, S, D)),
            "wqkv": _w((lambda *s: torch.randn(*s, dtype=torch.bfloat16) * 0.2)(D, 3 * D)),
            "w_phi": _w((lambda *s: torch.randn(*s, dtype=torch.bfloat16) * 0.2)(H, Dh, Dh) * (Dh ** -0.5)),
            "wo": _w((lambda *s: torch.randn(*s, dtype=torch.bfloat16) * 0.05)(D, D)),
        }
    _A_in = _A_setup()

    def _B_setup():
        B, S, D, F = 1, 2048, 640, 1728
        return {
            "x": _w((lambda *s: torch.randn(*s, dtype=torch.bfloat16) * 0.05)(B, S, D)),
            "w1": _w((lambda *s: torch.randn(*s, dtype=torch.bfloat16) * 0.05)(D, F)),
            "b1": _w((lambda *s: torch.randn(*s, dtype=torch.bfloat16) * 0.4)(F)),
            "w2": _w((lambda *s: torch.randn(*s, dtype=torch.bfloat16) * 0.05)(F, D)),
            "b2": _w((lambda *s: torch.randn(*s, dtype=torch.bfloat16) * 1.6)(D)),
        }
    _B_in = _B_setup()

    return {
        "A_x": _A_in["x"],
        "A_wqkv": _A_in["wqkv"],
        "A_w_phi": _A_in["w_phi"],
        "A_wo": _A_in["wo"],
        "B_x": _B_in["x"],
        "B_w1": _B_in["w1"],
        "B_b1": _B_in["b1"],
        "B_w2": _B_in["w2"],
        "B_b2": _B_in["b2"],
    }

def reference(A_x, A_wqkv, A_w_phi, A_wo, B_x, B_w1, B_b1, B_w2, B_b2):
    def _A_ref(x, wqkv, w_phi, wo):
        B, S, D = x.shape
        H = 32; Dh = D // H
        qkv = (lambda x, *d: x.permute(*d))((x @ wqkv).reshape(B, S, 3, H, Dh), 2, 0, 3, 1, 4)
        q, k, v = qkv[0], qkv[1], qkv[2]
        pq = torch.einsum("bhsd,hdf->bhsf", q, w_phi)
        pk = torch.einsum("bhsd,hdf->bhsf", k, w_phi)
        phi_q = torch.concatenate([_softmax(pq, axis=-1), _softmax(-pq, axis=-1)], axis=-1)
        phi_k = torch.concatenate([_softmax(pk, axis=-1), _softmax(-pk, axis=-1)], axis=-1)
        kv = torch.einsum("bhsf,bhsd->bhfd", phi_k, v)
        z  = torch.einsum("bhsf->bhf", phi_k)
        num = torch.einsum("bhqf,bhfd->bhqd", phi_q, kv)
        den = torch.einsum("bhqf,bhf->bhq", phi_q, z)[..., None] + 1e-6
        o = num / den
        return (lambda x, *d: x.permute(*d))(o, 0, 2, 1, 3).reshape(B, S, D) @ wo

    def _B_ref(x, w1, b1, w2, b2):
        h = torch.einsum("bsd,df->bsf", x, w1) + b1
        zero = torch.zeros_like(h)
        r = torch.where(h > zero, h, zero)
        h = r * r
        out = torch.einsum("bsf,fd->bsd", h, w2) + b2
        return out

    x = A_x
    h = x + _A_ref(_layernorm(x, axis=-1), A_wqkv, A_w_phi, A_wo)
    h2 = h + _B_ref(_layernorm(h, axis=-1), B_w1, B_b1, B_w2, B_b2)
    return h2
```

```asm
; @launch grid=(256,1,1) block=(256,1,1) lds=163840
.amdgcn_target "amdgcn-amd-amdhsa--gfx950"
.text
.globl sequential_preLN__linear_kernel_hedgehog__dense_activation_squared_relu__prompt_kernel
.p2align 8
.type sequential_preLN__linear_kernel_hedgehog__dense_activation_squared_relu__prompt_kernel,@function
sequential_preLN__linear_kernel_hedgehog__dense_activation_squared_relu__prompt_kernel:
    s_cmp_ge_u32 s2, 256
    s_cbranch_scc1 L_end
    s_load_dwordx16 s[32:47], s[0:1], 0
    s_load_dwordx8 s[48:55], s[0:1], 64
    s_getpc_b64 s[30:31]
L_pc:
    s_lshr_b32 s29, s2, 3
    s_lshl_b32 s56, s29, 11
    v_lshrrev_b32 v4, 4, v0
    v_lshl_add_u32 v4, v4, 7, s56
    v_min_u32 v4, L_last-L_pc, v4
    global_load_dword v255, v4, s[30:31]
    v_lshrrev_b32 v1, 6, v0
    v_and_b32 v0, 63, v0
    v_readfirstlane_b32 s3, v1
    s_and_b32 s28, s2, 7
    s_and_b32 s4, s28, 3
    s_lshl_b32 s4, s4, 2
    s_and_b32 s30, s29, 3
    s_add_u32 s4, s4, s30
    s_lshr_b32 s5, s28, 2
    s_lshl_b32 s5, s5, 3
    s_lshr_b32 s30, s29, 2
    s_add_u32 s5, s5, s30
    s_lshr_b32 s30, s2, 2
    s_xor_b32 s30, s30, s2
    s_andn2_b32 s30, 32, s30
    s_lshl_b32 s30, s30, 2
    s_lshr_b32 s31, s2, 6
    s_lshl_b32 s31, s31, 5
    s_or_b32 s30, s30, s31
    s_and_b32 s31, s2, 31
    s_or_b32 s101, s30, s31
    v_mov_b32 v3, 1073741824
    v_and_b32 v4, 3, v0
    v_lshrrev_b32 v6, 4, v0
    v_cmp_gt_u32 vcc, 48, v0
    v_lshrrev_b32 v5, 1, v4
    v_add_u32 v5, v4, v5
    v_cndmask_b32 v5, 2, v5, vcc
    v_cndmask_b32 v7, v4, v6, vcc
    v_add_u32 v8, 1, v7
    v_mul_u32_u24 v8, 1280, v8
    v_cmp_ne_u32 vcc, 2, v7
    v_bfe_u32 v9, v0, 2, 2
    v_mul_u32_u24 v9, 3840, v9
    v_cndmask_b32 v8, 0, v8, vcc
    v_lshl_add_u32 v8, v5, 4, v8
    v_cmp_ne_u32 vcc, 3, v7
    v_add_u32 v8, v8, v9
    s_mul_i32 s30, s4, 10
    s_add_u32 s30, s30, s3
    v_cndmask_b32 v14, v3, v8, vcc
    s_mul_i32 s56, s30, 15360
    s_mul_i32 s30, s5, 80
    s_add_u32 s56, s56, s30
    s_add_u32 s57, s56, 61440
    s_add_u32 s58, s56, 122880
    s_cmp_lt_u32 s3, 2
    s_cselect_b32 s58, s58, 1073741824
    s_lshl_b32 s61, s3, 10
    s_and_b32 s6, s2, 7
    s_lshl_b32 s6, s6, 1
    s_bfe_u32 s30, s2, 0x10003
    s_add_u32 s6, s6, s30
    s_lshr_b32 s7, s2, 4
    v_lshrrev_b32 v6, 4, v0
    v_lshrrev_b32 v4, 3, v0
    v_mul_u32_u24 v4, 1280, v4
    v_and_b32 v5, 7, v0
    v_xor_b32 v5, v5, v6
    v_lshlrev_b32 v5, 4, v5
    v_add_u32 v10, v4, v5
    v_xor_b32 v5, 64, v5
    v_add_u32 v11, v4, v5
    v_add_u32 v11, 10240, v11
    v_add_u32 v12, 20480, v10
    v_add_u32 v13, 20480, v11
    s_lshl_b32 s88, s4, 2
    s_add_u32 s88, s88, s3
    s_mul_i32 s88, s88, 40960
    s_and_b32 s30, s5, 7
    s_lshr_b32 s31, s30, 2
    s_add_u32 s30, s30, s31
    s_lshr_b32 s31, s5, 3
    s_add_u32 s92, s30, s31
    s_add_u32 s89, s88, 1280
    s_lshl_b32 s30, s92, 7
    s_add_u32 s88, s88, s30
    s_lshl_b32 s60, s3, 12
    s_add_u32 s60, s60, 49152
    v_lshlrev_b32 v1, 4, v0
    s_mov_b32 s10, 2621440
    s_mov_b32 s11, 0x20000
    s_mov_b32 s14, 2457600
    s_mov_b32 s15, 0x20000
    s_mov_b32 s18, 134217728
    s_mov_b32 s19, 0x20000
    s_waitcnt lgkmcnt(0)
    s_mov_b32 s12, s34
    s_mov_b32 s13, s35
    s_mov_b32 s8, s32
    s_mov_b32 s9, s33
    s_mov_b32 s16, s54
    s_mov_b32 s17, s55
    s_lshl_b32 s93, s3, 8
    s_add_u32 s93, s93, s101
    s_sub_u32 s93, s93, 785
    s_cmp_gt_u32 s93, 6
    s_cbranch_scc1 L_noprobe_1
    s_mul_i32 s62, s93, 1152
    s_and_b32 s63, s93, 1
    s_lshl_b32 s63, s63, 13
    s_add_u32 s62, s62, s63
    s_add_u32 s62, s62, 131072
    s_xor_b32 s63, s62, 0x2000
    s_load_dword s94, s[54:55], s62 glc
    s_load_dwordx2 s[0:1], s[54:55], s63 glc
L_noprobe_1:
    s_and_b32 s29, s101, 0xfffffff4
    s_cmp_lg_u32 s29, 4
    s_cbranch_scc1 L_noclr_2
    s_lshr_b32 s29, s101, 1
    s_and_b32 s29, s29, 4
    s_and_b32 s30, s101, 3
    s_or_b32 s29, s29, s30
    v_mov_b32 v128, 0
    v_mov_b32 v129, 0
    v_mov_b32 v130, 0
    v_mov_b32 v131, 0
    s_lshl_b32 s29, s29, 12
    s_add_u32 s29, s29, s61
    s_lshl_b32 s30, s29, 1
    buffer_store_dwordx4 v[128:131], v1, s[16:19], s30 offen sc1
    buffer_store_dwordx4 v[128:131], v1, s[16:19], s30 offen offset:1024 sc1
    s_and_b32 s30, s29, 0x6000
    s_add_u32 s29, s29, s30
    s_add_u32 s29, s29, 0x10000
    buffer_store_dwordx4 v[128:131], v1, s[16:19], s29 offen sc1
    s_nop 1
L_noclr_2:
    s_add_u32 m0, s61, 0
    s_nop 0
    buffer_load_dwordx4 v14, s[12:15], s56 offen lds
    s_add_u32 m0, s61, 4096
    s_nop 0
    buffer_load_dwordx4 v14, s[12:15], s57 offen lds
    s_add_u32 m0, s61, 8192
    s_nop 0
    buffer_load_dwordx4 v14, s[12:15], s58 offen lds
    s_cmp_gt_u32 s93, 6
    s_cbranch_scc1 L_noprobe_3
    s_mov_b32 s24, s52
    s_mov_b32 s25, s53
    s_mov_b32 s26, 256
    s_mov_b32 s27, 0x20000
    s_waitcnt lgkmcnt(0)
    s_load_dword s94, s[54:55], s62 glc
    s_load_dwordx2 s[0:1], s[54:55], s63 glc
    v_lshlrev_b32 v129, 8, v0
    s_lshl_b32 s30, s93, 2
    s_waitcnt lgkmcnt(2)
    s_nop 12
    s_getreg_b32 s29, hwreg(HW_REG_IB_STS, 8, 4)
    s_cmp_eq_u32 s29, 2
    s_cselect_b32 s28, s62, s63
    s_lshr_b32 s28, s28, 11
    s_xor_b32 s28, s28, s2
    s_bfe_u32 s28, s28, 0x10002
    s_add_u32 s28, s28, 1
    v_mov_b32 v128, s28
    buffer_store_dword v128, v129, s[24:27], s30 offen offset:128 sc1
    s_waitcnt lgkmcnt(0)
L_noprobe_3:
    s_mov_b64 s[90:91], s[36:37]
    s_sub_u32 s41, s101, 24
    s_cmp_lt_u32 s41, 152
    s_cselect_b32 s20, s46, s42
    s_cselect_b32 s21, s47, s43
    s_mov_b32 s22, 2211840
    s_mov_b32 s23, 0x20000
    s_cmp_lt_u32 s41, 40
    s_cmov_b32 s20, s38
    s_cmov_b32 s21, s39
    s_cmov_b32 s22, 819200
    v_lshrrev_b32 v4, 4, v0
    v_bfe_u32 v5, v0, 2, 2
    v_lshl_add_u32 v4, v4, 3, v5
    v_mul_u32_u24 v4, 960, v4
    v_and_b32 v5, 3, v0
    s_mul_i32 s33, s3, 7680
    s_add_u32 s33, s33, 114688
    s_cmp_lt_u32 s41, 152
    s_cbranch_scc0 L_pkb_5
    s_lshr_b32 s28, s41, 1
    s_and_b32 s40, s41, 1
    s_lshl_b32 s31, s40, 2
    s_add_u32 s31, s31, s3
    s_mov_b32 s42, 0
    s_cmp_lt_u32 s41, 40
    s_cbranch_scc1 L_pkwo_7
    s_sub_u32 s28, s28, 20
    s_mul_i32 s29, s28, 4682
    s_lshr_b32 s29, s29, 16
    s_mul_i32 s30, s29, 14
    s_sub_u32 s28, s28, s30
    s_lshr_b32 s34, s31, 1
    s_lshl_b32 s34, s34, 22
    s_and_b32 s31, s31, 1
    s_lshl_b32 s31, s31, 20
    s_add_u32 s34, s34, s31
    s_mul_i32 s31, s29, 156672
    s_add_u32 s34, s34, s31
    s_add_u32 s34, s34, 109051904
    s_mul_i32 s35, s28, 5
    s_lshr_b32 s30, s28, 1
    s_and_b32 s31, s28, 1
    s_lshl_b32 s31, s31, 2
    s_add_u32 s31, s31, s3
    s_sub_u32 s36, s28, 8
    s_add_u32 s37, s3, 8
    s_cmp_ge_u32 s28, 8
    s_cmov_b32 s30, s36
    s_cmov_b32 s31, s37
    s_sub_u32 s36, s28, 12
    s_lshl_b32 s36, s36, 1
    s_lshr_b32 s37, s3, 1
    s_add_u32 s36, s36, s37
    s_and_b32 s37, s3, 1
    s_add_u32 s37, s37, 12
    s_cmp_ge_u32 s28, 12
    s_cmov_b32 s30, s36
    s_cmov_b32 s31, s37
    s_cmp_eq_u32 s31, 13
    s_cmov_b32 s42, 1073741824
    s_lshl_b32 s29, s29, 2
    s_add_u32 s29, s29, s30
    s_mul_i32 s29, s29, 108
    s_lshl_b32 s31, s31, 3
    s_add_u32 s29, s29, s31
    s_branch L_pkc_8
L_pkwo_7:
    s_mul_i32 s29, s28, 52
    s_lshr_b32 s29, s29, 8
    s_lshl_b32 s31, s31, 18
    s_mul_i32 s34, s29, 74752
    s_add_u32 s34, s34, s31
    s_add_u32 s34, s34, 88080384
    s_mul_i32 s29, s29, 5
    s_sub_u32 s29, s28, s29
    s_mul_i32 s35, s29, 5
    s_lshl_b32 s29, s28, 2
    s_add_u32 s29, s29, s3
    s_lshl_b32 s29, s29, 3
L_pkc_8:
    s_mul_i32 s32, s29, 1280
    s_mul_i32 s30, s40, 640
    s_add_u32 s32, s32, s30
    s_mov_b32 s46, 1073741824
    s_mov_b32 s47, 4
    s_movk_i32 s38, 0
    s_movk_i32 s39, 1280
    s_movk_i32 s43, 0xff
    s_mov_b64 s[36:37], -1
    s_mul_i32 s30, s3, 160
    s_add_u32 s30, s30, 114688
    v_lshrrev_b32 v6, 1, v5
    v_mul_u32_u24 v6, 80, v6
    v_add3_u32 v4, v4, v6, s30
    v_and_b32 v5, 1, v5
    v_mul_u32_u24 v6, 48, v5
    v_add_u32 v24, v4, v6
    v_add_u32 v25, 16, v24
    v_mov_b32 v26, v24
    v_lshl_add_u32 v27, v5, 3, v4
    v_add_u32 v27, 32, v27
    s_branch L_pkd_6
L_pkb_5:
    s_sub_u32 s28, s41, 152
    s_and_b32 s40, s28, 3
    s_lshr_b32 s28, s28, 2
    s_and_b32 s28, s28, 31
    s_lshl_b32 s29, s28, 2
    s_add_u32 s29, s29, s3
    s_mul_i32 s29, s29, 27648
    s_mul_i32 s30, s40, 864
    s_add_u32 s32, s29, s30
    s_lshl_b32 s34, s40, 22
    s_mul_i32 s30, s3, 532480
    s_add_u32 s34, s34, s30
    s_add_u32 s34, s34, 92274688
    s_mul_i32 s35, s28, 7
    s_cmp_lt_u32 s101, 24
    s_cmov_b32 s32, 1073741824
    s_cmov_b32 s34, 1073741824
    s_mov_b32 s46, 0
    s_mov_b32 s47, 6
    s_movk_i32 s38, 0
    s_movk_i32 s39, 3456
    s_mov_b32 s43, 0x3fffff
    s_mov_b32 s42, 0
    s_mov_b32 s36, 0x0fff0fff
    s_mov_b32 s37, s36
    s_mul_i32 s30, s3, 216
    s_add_u32 s30, s30, 114688
    v_add_u32 v4, s30, v4
    v_lshl_add_u32 v24, v5, 4, v4
    v_add_u32 v25, 64, v24
    v_add_u32 v26, 128, v24
    v_lshl_add_u32 v27, v5, 3, v4
    v_add_u32 v27, 192, v27
L_pkd_6:
    s_add_u32 m0, s33, 0
    s_mov_b32 exec_hi, s43
    buffer_load_dwordx4 v1, s[20:23], s32 offen lds
    s_mov_b32 exec_hi, -1
    s_add_u32 s32, s32, s39
    s_add_u32 m0, s33, 960
    s_mov_b32 exec_hi, s43
    buffer_load_dwordx4 v1, s[20:23], s32 offen lds
    s_mov_b32 exec_hi, -1
    s_add_u32 s32, s32, s39
    s_add_u32 m0, s33, 1920
    s_mov_b32 exec_hi, s43
    buffer_load_dwordx4 v1, s[20:23], s32 offen lds
    s_mov_b32 exec_hi, -1
    s_add_u32 s32, s32, s39
    s_add_u32 m0, s33, 2880
    s_mov_b32 exec_hi, s43
    buffer_load_dwordx4 v1, s[20:23], s32 offen lds
    s_mov_b32 exec_hi, -1
    s_add_u32 s32, s32, s39
    s_lshr_b32 s28, s5, 2
    s_lshl_b32 s28, s28, 22
    s_and_b32 s29, s5, 3
    s_lshl_b32 s29, s29, 19
    s_add_u32 s28, s28, s29
    s_add_u32 s14, s28, 71303168
    s_and_b32 s28, s5, 8
    s_lshl_b32 s28, s28, 10
    s_add_u32 s14, s14, s28
    s_and_b32 s28, s2, 4
    s_lshl_b32 s15, s28, 11
    s_and_b32 s28, s6, 8
    s_lshl_b32 s28, s28, 10
    s_lshl_b32 s29, s6, 22
    s_add_u32 s28, s28, s29
    s_add_u32 s12, s28, 4194304
    s_and_b32 s28, s6, 1
    s_lshl_b32 s28, s28, 14
    s_and_b32 s29, s6, 2
    s_lshl_b32 s29, s29, 19
    s_add_u32 s28, s28, s29
    s_add_u32 s12, s12, s28
    s_and_b32 s28, s4, 8
    s_lshl_b32 s28, s28, 10
    s_add_u32 s32, s32, s42
    s_add_u32 m0, s33, 3840
    s_mov_b32 exec_hi, s43
    buffer_load_dwordx4 v1, s[20:23], s32 offen lds
    s_mov_b32 exec_hi, -1
    s_add_u32 s32, s32, s39
    s_lshl_b32 s29, s4, 22
    s_add_u32 s28, s28, s29
    s_add_u32 s13, s28, 4194304
    s_and_b32 s28, s4, 1
    s_lshl_b32 s28, s28, 14
    s_and_b32 s29, s4, 2
    s_lshl_b32 s29, s29, 19
    s_add_u32 s28, s28, s29
    s_add_u32 s13, s13, s28
    s_mov_b32 s100, 0x3f803f80
    v_bfe_u32 v4, v0, 4, 1
    v_and_b32 v5, 1, v0
    v_cmp_eq_u32 vcc, v4, v5
    v_mov_b32 v6, s100
    s_nop 0
    v_cndmask_b32 v6, 0, v6, vcc
    v_accvgpr_write_b32 a220, v6
    v_accvgpr_write_b32 a221, v6
    v_accvgpr_write_b32 a222, v6
    v_accvgpr_write_b32 a223, v6
    v_bfe_u32 v6, v0, 1, 1
    v_lshl_add_u32 v6, v4, 1, v6
    v_lshl_add_u32 v7, v5, 2, v6
    v_lshl_add_u32 v6, v6, 1, v5
    v_cmp_eq_u32_e64 vcc, 3, s3
    s_add_u32 m0, s33, 4800
    s_mov_b32 exec_hi, s43
    buffer_load_dwordx4 v1, s[20:23], s32 offen lds
    s_mov_b32 exec_hi, -1
    s_add_u32 s32, s32, s39
    v_bfe_u32 v8, v0, 2, 2
    v_lshrrev_b32 v5, 5, v0
    v_cndmask_b32 v7, v7, v6, vcc
    v_lshlrev_b32 v7, 3, v7
    v_lshl_add_u32 v7, v8, 6, v7
    v_lshl_add_u32 v7, v5, 11, v7
    s_lshl_b32 s28, s3, 8
    v_add_u32 v15, s28, v7
    s_mul_i32 s28, s4, 5
    v_add_u32 v5, s28, v5
    v_and_b32 v6, 1, v5
    v_lshrrev_b32 v5, 1, v5
    v_and_b32 v7, 31, v0
    v_lshlrev_b32 v7, 4, v7
    v_lshl_add_u32 v7, v6, 9, v7
    s_min_u32 s63, s3, 2
    s_mov_b32 s62, 3
    s_cmp_eq_u32 s3, 2
    s_cselect_b32 s28, 245760, 0
    s_cmov_b32 s62, 1
    s_cmov_b32 s63, 0
    v_add_u32 v7, s28, v7
    v_cmp_gt_u32 vcc, 32, v0
    v_mov_b32 v8, s63
    s_lshl_b32 s28, s92, 2
    v_subrev_u32 v5, s28, v5
    v_add_u32 v6, 40, v5
    v_min_u32 v6, v6, v5
    v_mad_u32_u24 v6, v6, s62, v8
    s_add_u32 m0, s33, 5760
    s_mov_b32 exec_hi, s43
    buffer_load_dwordx4 v1, s[20:23], s32 offen lds
    s_mov_b32 exec_hi, -1
    s_add_u32 s32, s32, s39
    v_lshl_add_u32 v16, v6, 10, v7
    v_lshrrev_b32 v6, 3, v6
    v_lshl_add_u32 v16, v6, 13, v16
    v_add_u32 v5, 1, v5
    v_add_u32 v6, 40, v5
    v_min_u32 v6, v6, v5
    v_mad_u32_u24 v6, v6, s62, v8
    v_lshl_add_u32 v28, v6, 10, v7
    v_lshrrev_b32 v6, 3, v6
    v_lshl_add_u32 v28, v6, 13, v28
    v_add_u32 v5, 1, v5
    v_add_u32 v6, 40, v5
    v_min_u32 v6, v6, v5
    v_mad_u32_u24 v6, v6, s62, v8
    v_lshl_add_u32 v17, v6, 10, v7
    v_lshrrev_b32 v6, 3, v6
    v_lshl_add_u32 v17, v6, 13, v17
    v_lshlrev_b32 v4, 2, v0
    v_cndmask_b32 v17, v3, v17, vcc
    s_lshl_b32 s29, s3, 7
    s_add_u32 s28, s29, 458752
    s_lshl_b32 s29, s4, 9
    s_add_u32 s29, s29, s28
    v_add_u32 v4, s29, v4
    s_add_u32 m0, s33, 6720
    s_mov_b32 exec_hi, s43
    buffer_load_dwordx4 v1, s[20:23], s32 offen lds
    s_mov_b32 exec_hi, -1
    s_add_u32 s32, s32, s39
    v_cndmask_b32 v18, v3, v4, vcc
    v_mov_b32 v19, s28
    s_mov_b32 s24, s52
    s_mov_b32 s25, s53
    s_mov_b32 s26, 256
    s_mov_b32 s27, 0x20000
    v_and_b32 v4, 31, v0
    v_lshlrev_b32 v5, 7, v4
    v_bfe_u32 v4, v0, 1, 3
    v_lshrrev_b32 v6, 5, v0
    v_xor_b32 v4, v4, v6
    v_lshl_add_u32 v20, v4, 4, v5
    v_add_u32 v20, s60, v20
    v_xor_b32 v21, 32, v20
    v_xor_b32 v22, 64, v20
    v_xor_b32 v23, 96, v20
    v_lshlrev_b32 v4, 4, v6
    v_add_u32 v39, 157696, v4
    v_and_b32 v33, 7, v0
    v_lshl_add_u32 v33, v33, 2, s61
    s_mov_b32 s96, 1069066811
    s_mov_b32 s97, 1069066811
    v_mov_b32 v4, s3
    v_lshl_add_u32 v4, v4, 6, v0
    v_cmp_gt_u32 vcc, 32, v4
    s_lshl_b32 s30, s2, 7
    s_and_b32 s31, s30, 0x6000
    s_add_u32 s30, s30, s31
    v_lshl_add_u32 v2, v0, 2, s30
    v_cndmask_b32 v2, v3, v2, vcc
    v_and_b32 v9, 15, v0
    v_mov_b32 v5, s5
    v_lshrrev_b32 v6, 2, v9
    v_lshrrev_b32 v7, 3, v5
    v_lshl_add_u32 v6, v7, 2, v6
    v_and_b32 v7, 3, v9
    v_lshl_add_u32 v6, v7, 3, v6
    v_and_b32 v7, 7, v5
    v_lshl_add_u32 v6, v7, 5, v6
    v_lshlrev_b32 v9, 7, v6
    v_and_b32 v6, 0x6000, v9
    v_add_u32 v9, v6, v9
    v_accvgpr_write_b32 a226, v9
    v_cmp_eq_u32_e64 vcc, 0, s3
    s_nop 1
    v_cndmask_b32 v9, v3, v9, vcc
    s_mov_b32 s20, s90
    s_mov_b32 s21, s91
    s_mov_b32 s22, 25600
    s_mov_b32 s23, 0x20000
    s_and_b32 s28, s3, 1
    s_mul_i32 s29, s28, 10
    v_add_u32 v4, s29, v0
    v_subrev_u32 v5, 50, v4
    v_min_u32 v4, v4, v5
    v_lshlrev_b32 v4, 4, v4
    s_lshl_b32 s29, s5, 1
    s_add_u32 s29, s29, s28
    s_mul_i32 s29, s29, 800
    s_cmp_lt_u32 s3, 2
    s_cselect_b32 s29, s29, 1073741824
    s_mov_b32 s30, 155648
    s_cmov_b32 s30, 158208
    s_lshl_b32 s28, s28, 10
    s_add_u32 s30, s30, s28
    s_mov_b32 m0, s30
    s_nop 0
    buffer_load_dwordx4 v4, s[20:23], s29 offen  lds
    s_waitcnt vmcnt(9)
    s_barrier
    ds_read_b64_tr_b16 v[64:65], v15 offset:0
    ds_read_b64_tr_b16 v[66:67], v15 offset:1024
    ds_read_b64_tr_b16 v[68:69], v15 offset:4096
    ds_read_b64_tr_b16 v[70:71], v15 offset:5120
    ds_read_b64_tr_b16 v[72:73], v15 offset:8192
    ds_read_b64_tr_b16 v[74:75], v15 offset:9216
    s_and_b32 s29, s101, 0xfffffff4
    s_cmp_lg_u32 s29, 4
    s_cbranch_scc1 L_noclr_9
    s_lshr_b32 s29, s101, 1
    s_and_b32 s29, s29, 4
    s_and_b32 s30, s101, 3
    s_or_b32 s29, s29, s30
    v_mov_b32 v128, 1
    v_lshlrev_b32 v129, 8, v0
    s_lshl_b32 s29, s29, 2
    s_add_u32 s29, s29, s61
    buffer_store_dword v128, v129, s[24:27], s29 offen sc1
    s_nop 1
L_noclr_9:
    s_add_u32 m0, s60, 0
    s_nop 0
    buffer_load_dwordx4 v10, s[8:11], s88 offen lds
    s_mov_b32 s28, 0xffff0000
    s_mov_b32 s29, s28
    s_waitcnt lgkmcnt(4)
    v_mfma_f32_16x16x32_bf16 v[76:79], a[220:223], v[64:67], 0
    s_waitcnt lgkmcnt(2)
    v_mfma_f32_16x16x32_bf16 v[76:79], a[220:223], v[68:71], v[76:79]
    s_waitcnt lgkmcnt(0)
    v_mfma_f32_16x16x32_bf16 v[76:79], a[220:223], v[72:75], v[76:79]
    s_lshr_b32 s31, s4, 1
    s_lshl_b32 s31, s31, 14
    s_and_b32 s30, s4, 1
    s_lshl_b32 s30, s30, 12
    s_add_u32 s31, s31, s30
    s_add_u32 s31, s31, 327680
    v_add_u32 v80, s61, v1
    v_cmp_gt_u32 vcc, 3840, v80
    v_add_u32 v80, s31, v80
    v_mov_b32 v84, -1
    v_mov_b32 v85, -1
    v_mov_b32 v86, -1
    v_mov_b32 v87, -1
    v_cndmask_b32 v80, v3, v80, vcc
    v_cndmask_b32 v76, v76, v77, s[28:29]
    s_add_u32 m0, s60, 1024
    s_nop 0
    buffer_load_dwordx4 v11, s[8:11], s88 offen lds
    v_lshrrev_b32 v4, 3, v0
    v_lshlrev_b32 v4, 9, v4
    v_and_b32 v5, 7, v0
    v_lshlrev_b32 v5, 4, v5
    v_add3_u32 v19, v4, v5, v19
    s_lshl_b32 s28, s3, 7
    s_add_u32 s28, s28, 157696
    v_add_u32 v38, s28, v5
    v_and_b32 v4, 1, v0
    v_lshlrev_b32 v4, 4, v4
    v_mov_b32 v5, 0x3f80
    v_lshlrev_b32 v4, v4, v5
    v_bfe_u32 v5, v0, 1, 1
    v_cmp_eq_u32 vcc, 0, v5
    s_nop 1
    v_cndmask_b32 v5, 0, v4, vcc
    v_accvgpr_write_b32 a224, v5
    v_cndmask_b32_e64 v5, v4, 0, vcc
    v_accvgpr_write_b32 a225, v5
    s_add_u32 m0, s60, 2048
    s_nop 0
    buffer_load_dwordx4 v12, s[8:11], s88 offen lds
    v_add_u32 v30, 114688, v1
    v_lshrrev_b32 v6, 5, v0
    v_and_b32 v4, 1, v0
    v_cmp_eq_u32 vcc, v4, v6
    v_bfe_u32 v4, v0, 4, 1
    v_bfe_u32 v5, v0, 1, 1
    v_lshl_add_u32 v4, v4, 1, v5
    v_cmp_eq_u32 s[30:31], 0, v4
    v_bfe_u32 v5, v0, 2, 2
    v_mul_u32_u24 v5, 40, v5
    v_lshl_add_u32 v5, v6, 10, v5
    v_lshl_add_u32 v5, v4, 3, v5
    v_add_u32 v5, 158208, v5
    v_mov_b32 v7, 155648
    v_cndmask_b32 v238, v7, v5, vcc
    v_cndmask_b32 v239, v7, v238, s[30:31]
    v_accvgpr_write_b32 a170, 0
    v_accvgpr_write_b32 a171, 0
    s_add_u32 m0, s60, 3072
    s_nop 0
    buffer_load_dwordx4 v13, s[8:11], s88 offen lds
    v_accvgpr_write_b32 a182, 0
    v_accvgpr_write_b32 a183, 0
    v_min_u32 v4, 39, v0
    s_lshr_b32 s28, s7, 3
    s_add_u32 s28, s28, 24
    v_lshl_add_u32 v5, v4, 1, s28
    s_lshr_b32 s28, s7, 2
    s_add_u32 s28, s28, 96
    v_lshl_add_u32 v6, v4, 2, s28
    v_cmp_gt_u32 vcc, 20, v4
    s_nop 1
    v_cndmask_b32 v37, v6, v5, vcc
    v_lshrrev_b32 v5, 1, v37
    v_xor_b32 v5, v5, v37
    v_not_b32 v5, v5
    v_bfe_u32 v5, v5, 6, 1
    v_bfe_u32 v6, v37, 5, 2
    v_lshl_add_u32 v5, v6, 1, v5
    v_and_b32 v37, 31, v37
    s_add_u32 m0, s60, 16384
    s_add_u32 s88, s88, 128
    s_cmp_eq_u32 s88, s89
    s_cselect_b32 s58, 1280, 0
    s_sub_u32 s88, s88, s58
    buffer_load_dwordx4 v10, s[8:11], s88 offen lds
    v_lshl_add_u32 v37, v5, 5, v37
    v_lshlrev_b32 v37, 7, v37
    v_and_b32 v6, 0x6000, v37
    v_add_u32 v37, v6, v37
    v_cmp_eq_u32_e64 vcc, 0, s3
    s_nop 1
    v_cndmask_b32 v37, v3, v37, vcc
    v_bfe_u32 v4, v0, 1, 1
    v_lshlrev_b32 v4, 2, v4
    v_and_b32 v5, 1, v0
    v_lshl_add_u32 v4, v5, 1, v4
    v_bfe_u32 v5, v0, 2, 1
    v_add_u32 v4, v4, v5
    v_and_b32 v5, 31, v0
    v_lshlrev_b32 v5, 7, v5
    v_lshl_add_u32 v4, v4, 4, v5
    v_lshrrev_b32 v5, 5, v0
    v_lshl_add_u32 v4, v5, 14, v4
    s_add_u32 s28, s60, 32768
    s_add_u32 m0, s60, 17408
    s_nop 0
    buffer_load_dwordx4 v11, s[8:11], s88 offen lds
    v_add_u32 v240, s28, v4
    v_xor_b32 v241, 16, v240
    v_xor_b32 v242, 32, v240
    v_xor_b32 v243, 48, v240
    v_xor_b32 v244, 64, v240
    v_xor_b32 v245, 80, v240
    v_xor_b32 v246, 96, v240
    v_xor_b32 v247, 112, v240
    v_bfe_u32 v4, v0, 3, 1
    v_lshlrev_b32 v4, 2, v4
    v_bfe_u32 v5, v0, 2, 1
    v_lshl_add_u32 v4, v5, 1, v4
    v_bfe_u32 v5, v0, 2, 2
    v_lshrrev_b32 v6, 5, v0
    v_lshl_add_u32 v5, v6, 3, v5
    v_lshlrev_b32 v5, 7, v5
    s_lshr_b32 s28, s3, 1
    s_lshl_b32 s28, s28, 14
    s_add_u32 m0, s60, 18432
    s_nop 0
    buffer_load_dwordx4 v12, s[8:11], s88 offen lds
    s_add_u32 s28, s28, 81920
    v_add_u32 v5, s28, v5
    v_bfe_u32 v6, v0, 4, 1
    v_and_b32 v7, 1, v0
    v_lshl_add_u32 v7, v6, 1, v7
    s_and_b32 s28, s3, 1
    v_cmp_eq_u32_e64 vcc, 1, s28
    s_nop 1
    v_cndmask_b32_e64 v7, v7, 4, vcc
    v_xor_b32 v7, v7, v4
    v_lshl_add_u32 v7, v7, 4, v5
    v_bfe_u32 v36, v0, 1, 1
    v_lshl_add_u32 v248, v36, 3, v7
    v_xor_b32 v249, 16, v248
    v_lshl_add_u32 v7, v6, 1, v36
    v_add_u32 v7, 5, v7
    v_min_u32 v7, 7, v7
    v_xor_b32 v7, v7, v4
    v_lshl_add_u32 v7, v7, 4, v5
    s_add_u32 m0, s60, 19456
    s_nop 0
    buffer_load_dwordx4 v13, s[8:11], s88 offen lds
    v_and_b32 v36, 1, v0
    v_lshl_add_u32 v250, v36, 3, v7
    v_xor_b32 v251, 16, v250
    v_and_b32 v4, 31, v0
    v_lshrrev_b32 v5, 5, v0
    v_mul_u32_u24 v6, 384, v5
    v_lshl_add_u32 v6, v4, 4, v6
    v_cmp_gt_u32 s[30:31], 24, v4
    v_add_u32 v7, 768, v6
    s_nop 0
    v_cndmask_b32 v252, v3, v6, s[30:31]
    v_cndmask_b32 v253, v3, v7, s[30:31]
    v_add_u32 v7, 1536, v1
    v_cmp_gt_u32 s[30:31], 24, v0
    s_nop 1
    v_cndmask_b32 v7, v3, v7, s[30:31]
    v_cndmask_b32 v252, v252, v7, vcc
    v_cndmask_b32 v253, v253, v3, vcc
    s_lshr_b32 s29, s4, 1
    s_lshl_b32 s29, s29, 14
    s_add_u32 m0, s60, 32768
    s_add_u32 s88, s88, 128
    s_cmp_eq_u32 s88, s89
    s_cselect_b32 s58, 1280, 0
    s_sub_u32 s88, s88, s58
    buffer_load_dwordx4 v10, s[8:11], s88 offen lds
    s_and_b32 s30, s4, 1
    s_lshl_b32 s30, s30, 12
    s_add_u32 s29, s29, s30
    s_lshr_b32 s28, s3, 1
    s_mul_i32 s28, s28, 1920
    s_add_u32 s29, s29, s28
    s_add_u32 s29, s29, 327680
    v_add_u32 v252, s29, v252
    v_add_u32 v253, s29, v253
    v_mov_b32 v50, 0
    v_mov_b32 v51, 0
    v_mov_b32 v62, 0x3f80
    v_mov_b32 v63, 0
    v_min_u32 v4, 55, v0
    s_lshr_b32 s28, s7, 3
    s_add_u32 s28, s28, 64
    v_lshl_add_u32 v36, v4, 1, s28
    v_lshrrev_b32 v5, 1, v36
    s_add_u32 m0, s60, 33792
    s_nop 0
    buffer_load_dwordx4 v11, s[8:11], s88 offen lds
    v_xor_b32 v5, v5, v36
    v_not_b32 v5, v5
    v_bfe_u32 v5, v5, 6, 1
    v_bfe_u32 v6, v36, 5, 2
    v_lshl_add_u32 v5, v6, 1, v5
    v_and_b32 v36, 31, v36
    v_lshl_add_u32 v36, v5, 5, v36
    v_lshlrev_b32 v36, 7, v36
    v_and_b32 v6, 0x6000, v36
    v_add_u32 v36, v6, v36
    v_cmp_eq_u32_e64 vcc, 0, s3
    s_nop 1
    v_cndmask_b32 v36, v3, v36, vcc
    s_lshr_b32 s101, s7, 1
    s_mov_b32 s95, 0x10000
    s_mov_b32 s57, s3
    s_and_b32 s59, s7, 1
    s_lshl_b32 s59, s59, 2
    s_lshl_b32 s28, s6, 3
    s_add_u32 m0, s60, 34816
    s_nop 0
    buffer_load_dwordx4 v12, s[8:11], s88 offen lds
    s_add_u32 s59, s59, s28
    s_lshl_b32 s28, s101, 18
    s_mul_i32 s29, s57, 74752
    s_add_u32 s28, s28, s29
    s_add_u32 s56, s28, 88080384
    v_mul_u32_u24 v4, 6554, v0
    v_lshrrev_b32 v4, 16, v4
    v_mul_u32_u24 v4, 1120, v4
    v_cmp_gt_u32 vcc, 60, v0
    s_add_u32 s28, s59, s3
    s_mul_i32 s28, s28, 20480
    s_mul_i32 s29, s101, 160
    s_add_u32 s28, s28, s29
    v_add3_u32 v4, v4, v1, s28
    v_cndmask_b32 v14, v3, v4, vcc
    v_cmp_gt_u32 vcc, 40, v0
    v_and_b32 v5, 15, v0
    v_mul_u32_u24 v6, 43, v5
    v_min_u32 v88, 6, v0
    v_lshlrev_b32 v88, 2, v88
    buffer_load_dword v89, v88, s[24:27], 0 offen offset:128 sc1
    s_add_u32 m0, s60, 35840
    s_nop 0
    buffer_load_dwordx4 v13, s[8:11], s88 offen lds
    v_cndmask_b32 v15, v3, v4, vcc
    v_lshrrev_b32 v6, 8, v6
    v_lshlrev_b32 v6, 6, v6
    v_mul_u32_u24 v5, 160, v5
    v_lshrrev_b32 v7, 5, v0
    v_mul_u32_u24 v7, 80, v7
    v_add3_u32 v5, v5, v6, v7
    s_lshl_b32 s42, s3, 12
    s_add_u32 s42, s42, 81920
    v_bfe_u32 v6, v0, 4, 1
    v_mul_u32_u24 v7, 48, v6
    v_add3_u32 v152, v5, v7, s42
    v_lshl_add_u32 v5, v6, 3, v5
    v_add3_u32 v153, v5, 32, s42
    s_lshr_b32 s41, s7, 2
    s_lshl_b32 s41, s41, 22
    s_and_b32 s28, s7, 3
    s_mul_i32 s28, s28, 532480
    s_waitcnt vmcnt(14)
    s_barrier
    ds_read_b64_tr_b16 v[156:157], v24 offset:0
    ds_read_b64_tr_b16 v[158:159], v24 offset:3840
    ds_read_b64_tr_b16 v[160:161], v24 offset:8
    ds_read_b64_tr_b16 v[162:163], v24 offset:3848
    ds_read_b64_tr_b16 v[164:165], v25 offset:0
    ds_read_b64_tr_b16 v[166:167], v25 offset:3840
    ds_read_b64_tr_b16 v[168:169], v25 offset:8
    ds_read_b64_tr_b16 v[170:171], v25 offset:3848
    ds_read_b64_tr_b16 v[172:173], v26 offset:0
    ds_read_b64_tr_b16 v[174:175], v26 offset:3840
    ds_read_b64_tr_b16 v[176:177], v26 offset:8
    ds_read_b64_tr_b16 v[178:179], v26 offset:3848
    ds_read_b64_tr_b16 v[180:181], v27 offset:0
    ds_read_b64_tr_b16 v[182:183], v27 offset:3840
    s_add_u32 m0, s60, 49152
    s_add_u32 s88, s88, 128
    s_cmp_eq_u32 s88, s89
    s_cselect_b32 s58, 1280, 0
    s_sub_u32 s88, s88, s58
    buffer_load_dwordx4 v10, s[8:11], s88 offen lds
    s_add_u32 s41, s41, s28
    s_add_u32 s41, s41, 92274688
    s_add_u32 s41, s41, s61
    s_add_u32 m0, s60, 50176
    s_nop 0
    buffer_load_dwordx4 v11, s[8:11], s88 offen lds
    s_add_u32 m0, s60, 51200
    s_nop 0
    buffer_load_dwordx4 v12, s[8:11], s88 offen lds
    s_add_u32 m0, s60, 52224
    s_nop 0
    buffer_load_dwordx4 v13, s[8:11], s88 offen lds
    s_waitcnt vmcnt(13)
    ds_read_b128 a[0:3], v20 offset:0
    ds_read_b128 a[4:7], v21 offset:0
    ds_read_b128 a[8:11], v22 offset:0
    ds_read_b128 a[12:15], v23 offset:0
    s_waitcnt vmcnt(9)
    ds_read_b128 a[16:19], v20 offset:16384
    ds_read_b128 a[20:23], v21 offset:16384
    ds_read_b128 a[24:27], v22 offset:16384
    ds_read_b128 a[28:31], v23 offset:16384
    s_waitcnt lgkmcnt(4)
    v_mfma_f32_16x16x32_bf16 v[112:115], a[220:223], a[0:3], 0
    v_mfma_f32_4x4x4_16b_bf16 v[116:119], a[0:1], a[0:1], 0
    v_mfma_f32_4x4x4_16b_bf16 v[120:123], a[2:3], a[2:3], 0
    s_add_u32 m0, s60, 0
    s_add_u32 s88, s88, 128
    s_cmp_eq_u32 s88, s89
    s_cselect_b32 s58, 1280, 0
    s_sub_u32 s88, s88, s58
    buffer_load_dwordx4 v10, s[8:11], s88 offen lds
    v_mfma_f32_16x16x32_bf16 v[112:115], a[220:223], a[4:7], v[112:115]
    v_mfma_f32_4x4x4_16b_bf16 v[124:127], a[4:5], a[4:5], 0
    v_mfma_f32_4x4x4_16b_bf16 v[128:131], a[6:7], a[6:7], 0
    s_add_u32 m0, s60, 1024
    s_nop 0
    buffer_load_dwordx4 v11, s[8:11], s88 offen lds
    v_mfma_f32_16x16x32_bf16 v[112:115], a[220:223], a[8:11], v[112:115]
    v_mfma_f32_4x4x4_16b_bf16 v[116:119], a[8:9], a[8:9], v[116:119]
    v_mfma_f32_4x4x4_16b_bf16 v[120:123], a[10:11], a[10:11], v[120:123]
    s_add_u32 m0, s60, 2048
    s_nop 0
    buffer_load_dwordx4 v12, s[8:11], s88 offen lds
    v_mfma_f32_16x16x32_bf16 v[112:115], a[220:223], a[12:15], v[112:115]
    v_mfma_f32_4x4x4_16b_bf16 v[124:127], a[12:13], a[12:13], v[124:127]
    v_mfma_f32_4x4x4_16b_bf16 v[128:131], a[14:15], a[14:15], v[128:131]
    s_add_u32 m0, s60, 3072
    s_nop 0
    buffer_load_dwordx4 v13, s[8:11], s88 offen lds
    s_waitcnt vmcnt(8)
    ds_read_b128 a[32:35], v20 offset:32768
    ds_read_b128 a[36:39], v21 offset:32768
    ds_read_b128 a[40:43], v22 offset:32768
    ds_read_b128 a[44:47], v23 offset:32768
    s_waitcnt lgkmcnt(4)
    v_mfma_f32_16x16x32_bf16 v[112:115], a[220:223], a[16:19], v[112:115]
    v_mfma_f32_4x4x4_16b_bf16 v[116:119], a[16:17], a[16:17], v[116:119]
    v_mfma_f32_4x4x4_16b_bf16 v[120:123], a[18:19], a[18:19], v[120:123]
    s_add_u32 m0, s60, 16384
    s_add_u32 s88, s88, 128
    s_cmp_eq_u32 s88, s89
    s_cselect_b32 s58, 1280, 0
    s_sub_u32 s88, s88, s58
    buffer_load_dwordx4 v10, s[8:11], s88 offen lds
    v_mfma_f32_16x16x32_bf16 v[112:115], a[220:223], a[20:23], v[112:115]
    v_mfma_f32_4x4x4_16b_bf16 v[124:127], a[20:21], a[20:21], v[124:127]
    v_mfma_f32_4x4x4_16b_bf16 v[128:131], a[22:23], a[22:23], v[128:131]
    buffer_load_dword v31, v33, s[24:27], 0 offen sc1
    v_cmp_eq_u32 s[0:1], 0, v89
    s_nop 0
    s_cmp_eq_u64 s[0:1], 0
    s_cbranch_scc0 L_pol_10
L_polok_11:
    v_cmp_eq_u32 s[0:1], 2, v89
    s_nop 0
    s_and_b32 s0, s0, 0x7f
    s_bcnt1_i32_b32 s0, s0
    s_and_b32 s0, s0, 4
    s_lshl_b32 s0, s0, 11
    s_xor_b32 s14, s14, s0
    s_xor_b32 s12, s12, s0
    s_xor_b32 s13, s13, s0
    s_xor_b32 s15, s15, s0
    s_xor_b32 s92, s12, 1048576
    s_add_u32 s62, s14, s61
    buffer_store_dwordx4 v[64:67], v16, s[16:19], s14 offen sc1
    buffer_store_dwordx4 v[68:71], v28, s[16:19], s14 offen sc1
    buffer_store_dwordx4 v[72:75], v17, s[16:19], s14 offen sc1
    buffer_store_dword v76, v18, s[16:19], s14 offen sc1
    buffer_store_dwordx4 v[84:87], v80, s[16:19], s14 offen sc1
    s_add_u32 m0, s60, 17408
    s_nop 0
    buffer_load_dwordx4 v11, s[8:11], s88 offen lds
    v_mfma_f32_16x16x32_bf16 v[112:115], a[220:223], a[24:27], v[112:115]
    v_mfma_f32_4x4x4_16b_bf16 v[116:119], a[24:25], a[24:25], v[116:119]
    v_mfma_f32_4x4x4_16b_bf16 v[120:123], a[26:27], a[26:27], v[120:123]
    s_add_u32 m0, s60, 18432
    s_nop 0
    buffer_load_dwordx4 v12, s[8:11], s88 offen lds
    s_add_u32 s32, s35, 0
    s_lshr_b32 s33, s32, 3
    s_mul_i32 s33, s33, s38
    s_lshl_b32 s32, s32, 10
    s_add_u32 s32, s32, s33
    s_add_u32 s32, s32, s34
    buffer_store_dwordx4 v[156:159], v1, s[16:19], s32 offen sc1
    v_mfma_f32_16x16x32_bf16 v[112:115], a[220:223], a[28:31], v[112:115]
    v_mfma_f32_4x4x4_16b_bf16 v[124:127], a[28:29], a[28:29], v[124:127]
    v_mfma_f32_4x4x4_16b_bf16 v[128:131], a[30:31], a[30:31], v[128:131]
    s_add_u32 m0, s60, 19456
    s_nop 0
    buffer_load_dwordx4 v13, s[8:11], s88 offen lds
    s_add_u32 s32, s35, 1
    s_lshr_b32 s33, s32, 3
    s_mul_i32 s33, s33, s38
    s_lshl_b32 s32, s32, 10
    s_add_u32 s32, s32, s33
    s_add_u32 s32, s32, s34
    buffer_store_dwordx4 v[160:163], v1, s[16:19], s32 offen sc1
    s_waitcnt vmcnt(5)
    v_mov_b32 v8, 1
    s_waitcnt lgkmcnt(0)
    s_barrier
    buffer_store_dword v8, v2, s[16:19], s15 offen sc1
    ds_read_b128 a[48:51], v20 offset:49152
    ds_read_b128 a[52:55], v21 offset:49152
    ds_read_b128 a[56:59], v22 offset:49152
    ds_read_b128 a[60:63], v23 offset:49152
    v_mfma_f32_16x16x32_bf16 v[112:115], a[220:223], a[32:35], v[112:115]
    v_mfma_f32_4x4x4_16b_bf16 v[116:119], a[32:33], a[32:33], v[116:119]
    v_mfma_f32_4x4x4_16b_bf16 v[120:123], a[34:35], a[34:35], v[120:123]
    s_add_u32 m0, s60, 32768
    s_add_u32 s88, s88, 128
    s_cmp_eq_u32 s88, s89
    s_cselect_b32 s58, 1280, 0
    s_sub_u32 s88, s88, s58
    buffer_load_dwordx4 v10, s[8:11], s88 offen lds
    s_add_u32 s32, s35, 2
    s_lshr_b32 s33, s32, 3
    s_mul_i32 s33, s33, s38
    s_lshl_b32 s32, s32, 10
    s_add_u32 s32, s32, s33
    s_add_u32 s32, s32, s34
    buffer_store_dwordx4 v[164:167], v1, s[16:19], s32 offen sc1
    v_mfma_f32_16x16x32_bf16 v[112:115], a[220:223], a[36:39], v[112:115]
    v_mfma_f32_4x4x4_16b_bf16 v[124:127], a[36:37], a[36:37], v[124:127]
    v_mfma_f32_4x4x4_16b_bf16 v[128:131], a[38:39], a[38:39], v[128:131]
    s_add_u32 m0, s60, 33792
    s_nop 0
    buffer_load_dwordx4 v11, s[8:11], s88 offen lds
    v_mfma_f32_16x16x32_bf16 v[112:115], a[220:223], a[40:43], v[112:115]
    v_mfma_f32_4x4x4_16b_bf16 v[116:119], a[40:41], a[40:41], v[116:119]
    v_mfma_f32_4x4x4_16b_bf16 v[120:123], a[42:43], a[42:43], v[120:123]
    s_add_u32 m0, s60, 34816
    s_nop 0
    buffer_load_dwordx4 v12, s[8:11], s88 offen lds
    s_add_u32 s32, s35, 3
    s_lshr_b32 s33, s32, 3
    s_mul_i32 s33, s33, s38
    s_lshl_b32 s32, s32, 10
    s_add_u32 s32, s32, s33
    s_add_u32 s32, s32, s34
    buffer_store_dwordx4 v[168:171], v1, s[16:19], s32 offen sc1
    v_mfma_f32_16x16x32_bf16 v[112:115], a[220:223], a[44:47], v[112:115]
    v_mfma_f32_4x4x4_16b_bf16 v[124:127], a[44:45], a[44:45], v[124:127]
    v_mfma_f32_4x4x4_16b_bf16 v[128:131], a[46:47], a[46:47], v[128:131]
    s_add_u32 m0, s60, 35840
    s_nop 0
    buffer_load_dwordx4 v13, s[8:11], s88 offen lds
    s_add_u32 s32, s35, 4
    s_lshr_b32 s33, s32, 3
    s_mul_i32 s33, s33, s38
    s_lshl_b32 s32, s32, 10
    s_add_u32 s32, s32, s33
    s_add_u32 s32, s32, s34
    s_add_u32 s32, s32, s46
    buffer_store_dwordx4 v[172:175], v1, s[16:19], s32 offen sc1
    ds_read_b128 a[64:67], v20 offset:0
    ds_read_b128 a[68:71], v21 offset:0
    ds_read_b128 a[72:75], v22 offset:0
    ds_read_b128 a[76:79], v23 offset:0
    s_waitcnt lgkmcnt(4)
    v_mfma_f32_16x16x32_bf16 v[112:115], a[220:223], a[48:51], v[112:115]
    v_mfma_f32_4x4x4_16b_bf16 v[116:119], a[48:49], a[48:49], v[116:119]
    v_mfma_f32_4x4x4_16b_bf16 v[120:123], a[50:51], a[50:51], v[120:123]
    s_add_u32 m0, s60, 49152
    s_add_u32 s88, s88, 128
    s_cmp_eq_u32 s88, s89
    s_cselect_b32 s58, 1280, 0
    s_sub_u32 s88, s88, s58
    buffer_load_dwordx4 v10, s[8:11], s88 offen lds
    s_add_u32 s32, s35, 5
    s_lshr_b32 s33, s32, 3
    s_mul_i32 s33, s33, s38
    s_lshl_b32 s32, s32, 10
    s_add_u32 s32, s32, s33
    s_add_u32 s32, s32, s34
    s_add_u32 s32, s32, s46
    buffer_store_dwordx4 v[176:179], v1, s[16:19], s32 offen sc1
    v_mfma_f32_16x16x32_bf16 v[112:115], a[220:223], a[52:55], v[112:115]
    v_mfma_f32_4x4x4_16b_bf16 v[124:127], a[52:53], a[52:53], v[124:127]
    v_mfma_f32_4x4x4_16b_bf16 v[128:131], a[54:55], a[54:55], v[128:131]
    s_add_u32 m0, s60, 50176
    s_nop 0
    buffer_load_dwordx4 v11, s[8:11], s88 offen lds
    v_mfma_f32_16x16x32_bf16 v[112:115], a[220:223], a[56:59], v[112:115]
    v_mfma_f32_4x4x4_16b_bf16 v[116:119], a[56:57], a[56:57], v[116:119]
    v_mfma_f32_4x4x4_16b_bf16 v[120:123], a[58:59], a[58:59], v[120:123]
    s_add_u32 m0, s60, 51200
    s_nop 0
    buffer_load_dwordx4 v12, s[8:11], s88 offen lds
    v_cndmask_b32 v180, 0, v180, s[36:37]
    v_cndmask_b32 v181, 0, v181, s[36:37]
    v_cndmask_b32 v182, 0, v182, s[36:37]
    v_cndmask_b32 v183, 0, v183, s[36:37]
    s_add_u32 s32, s35, s47
    s_lshr_b32 s33, s32, 3
    s_mul_i32 s33, s33, s38
    s_lshl_b32 s32, s32, 10
    s_add_u32 s32, s32, s33
    s_add_u32 s32, s32, s34
    buffer_store_dwordx4 v[180:183], v1, s[16:19], s32 offen sc1
    v_mfma_f32_16x16x32_bf16 v[112:115], a[220:223], a[60:63], v[112:115]
    v_mfma_f32_4x4x4_16b_bf16 v[124:127], a[60:61], a[60:61], v[124:127]
    v_mfma_f32_4x4x4_16b_bf16 v[128:131], a[62:63], a[62:63], v[128:131]
    s_add_u32 m0, s60, 52224
    s_nop 0
    buffer_load_dwordx4 v13, s[8:11], s88 offen lds
    s_waitcnt vmcnt(15)
    ds_read_b128 a[80:83], v20 offset:16384
    ds_read_b128 a[84:87], v21 offset:16384
    ds_read_b128 a[88:91], v22 offset:16384
    ds_read_b128 a[92:95], v23 offset:16384
    s_waitcnt lgkmcnt(4)
    v_mfma_f32_16x16x32_bf16 v[112:115], a[220:223], a[64:67], v[112:115]
    v_mfma_f32_4x4x4_16b_bf16 v[116:119], a[64:65], a[64:65], v[116:119]
    v_mfma_f32_4x4x4_16b_bf16 v[120:123], a[66:67], a[66:67], v[120:123]
    s_add_u32 m0, s60, 0
    s_add_u32 s88, s88, 128
    s_cmp_eq_u32 s88, s89
    s_cselect_b32 s58, 1280, 0
    s_sub_u32 s88, s88, s58
    buffer_load_dwordx4 v10, s[8:11], s88 offen lds
    v_mfma_f32_16x16x32_bf16 v[112:115], a[220:223], a[68:71], v[112:115]
    v_mfma_f32_4x4x4_16b_bf16 v[124:127], a[68:69], a[68:69], v[124:127]
    v_mfma_f32_4x4x4_16b_bf16 v[128:131], a[70:71], a[70:71], v[128:131]
    s_add_u32 m0, s60, 1024
    s_nop 0
    buffer_load_dwordx4 v11, s[8:11], s88 offen lds
    v_mfma_f32_16x16x32_bf16 v[112:115], a[220:223], a[72:75], v[112:115]
    v_mfma_f32_4x4x4_16b_bf16 v[116:119], a[72:73], a[72:73], v[116:119]
    v_mfma_f32_4x4x4_16b_bf16 v[120:123], a[74:75], a[74:75], v[120:123]
    s_add_u32 m0, s60, 2048
    s_nop 0
    buffer_load_dwordx4 v12, s[8:11], s88 offen lds
    v_mfma_f32_16x16x32_bf16 v[112:115], a[220:223], a[76:79], v[112:115]
    v_mfma_f32_4x4x4_16b_bf16 v[124:127], a[76:77], a[76:77], v[124:127]
    v_mfma_f32_4x4x4_16b_bf16 v[128:131], a[78:79], a[78:79], v[128:131]
    s_add_u32 m0, s60, 3072
    s_nop 0
    buffer_load_dwordx4 v13, s[8:11], s88 offen lds
    s_cmp_lg_u32 s3, 0
    s_cbranch_scc1 L_polled_13
    v_cmp_gt_u32 s[0:1], 1, v31
    s_mov_b32 s94, 0
    s_cmp_eq_u64 s[0:1], 0
    s_cbranch_scc1 L_polled_13
L_poll_12:
    s_sleep 4
    s_add_u32 s94, s94, 1
    buffer_load_dword v31, v33, s[24:27], 0 offen sc1
    s_cmp_gt_u32 s94, 0x40000
    s_cbranch_scc1 L_polled_13
    s_waitcnt vmcnt(0)
    v_cmp_gt_u32 s[0:1], 1, v31
    s_nop 0
    s_cmp_eq_u64 s[0:1], 0
    s_cbranch_scc0 L_poll_12
L_polled_13:
    buffer_load_dword v8, v9, s[16:19], s15 offen sc1
    buffer_store_dword v31, v2, s[16:19], s15 offen sc1
    s_waitcnt vmcnt(13)
    ds_read_b128 a[96:99], v20 offset:32768
    ds_read_b128 a[100:103], v21 offset:32768
    ds_read_b128 a[104:107], v22 offset:32768
    ds_read_b128 a[108:111], v23 offset:32768
    s_waitcnt lgkmcnt(4)
    v_mfma_f32_16x16x32_bf16 v[112:115], a[220:223], a[80:83], v[112:115]
    v_mfma_f32_4x4x4_16b_bf16 v[116:119], a[80:81], a[80:81], v[116:119]
    v_mfma_f32_4x4x4_16b_bf16 v[120:123], a[82:83], a[82:83], v[120:123]
    s_add_u32 m0, s60, 16384
    s_add_u32 s88, s88, 128
    s_cmp_eq_u32 s88, s89
    s_cselect_b32 s58, 1280, 0
    s_sub_u32 s88, s88, s58
    buffer_load_dwordx4 v10, s[8:11], s88 offen lds
    v_mfma_f32_16x16x32_bf16 v[112:115], a[220:223], a[84:87], v[112:115]
    v_mfma_f32_4x4x4_16b_bf16 v[124:127], a[84:85], a[84:85], v[124:127]
    v_mfma_f32_4x4x4_16b_bf16 v[128:131], a[86:87], a[86:87], v[128:131]
    s_add_u32 m0, s60, 17408
    s_nop 0
    buffer_load_dwordx4 v11, s[8:11], s88 offen lds
    v_mfma_f32_16x16x32_bf16 v[112:115], a[220:223], a[88:91], v[112:115]
    v_mfma_f32_4x4x4_16b_bf16 v[116:119], a[88:89], a[88:89], v[116:119]
    v_mfma_f32_4x4x4_16b_bf16 v[120:123], a[90:91], a[90:91], v[120:123]
    s_add_u32 m0, s60, 18432
    s_nop 0
    buffer_load_dwordx4 v12, s[8:11], s88 offen lds
    v_mfma_f32_16x16x32_bf16 v[112:115], a[220:223], a[92:95], v[112:115]
    v_mfma_f32_4x4x4_16b_bf16 v[124:127], a[92:93], a[92:93], v[124:127]
    v_mfma_f32_4x4x4_16b_bf16 v[128:131], a[94:95], a[94:95], v[128:131]
    s_add_u32 m0, s60, 19456
    s_nop 0
    buffer_load_dwordx4 v13, s[8:11], s88 offen lds
    s_waitcnt vmcnt(10)
    ds_read_b128 a[112:115], v20 offset:49152
    ds_read_b128 a[116:119], v21 offset:49152
    ds_read_b128 a[120:123], v22 offset:49152
    ds_read_b128 a[124:127], v23 offset:49152
    s_waitcnt lgkmcnt(4)
    v_mfma_f32_16x16x32_bf16 v[112:115], a[220:223], a[96:99], v[112:115]
    v_mfma_f32_4x4x4_16b_bf16 v[116:119], a[96:97], a[96:97], v[116:119]
    v_mfma_f32_4x4x4_16b_bf16 v[120:123], a[98:99], a[98:99], v[120:123]
    v_mfma_f32_16x16x32_bf16 v[112:115], a[220:223], a[100:103], v[112:115]
    v_mfma_f32_4x4x4_16b_bf16 v[124:127], a[100:101], a[100:101], v[124:127]
    v_mfma_f32_4x4x4_16b_bf16 v[128:131], a[102:103], a[102:103], v[128:131]
    v_mfma_f32_16x16x32_bf16 v[112:115], a[220:223], a[104:107], v[112:115]
    v_mfma_f32_4x4x4_16b_bf16 v[116:119], a[104:105], a[104:105], v[116:119]
    v_mfma_f32_4x4x4_16b_bf16 v[120:123], a[106:107], a[106:107], v[120:123]
    v_mfma_f32_16x16x32_bf16 v[112:115], a[220:223], a[108:111], v[112:115]
    v_mfma_f32_4x4x4_16b_bf16 v[124:127], a[108:109], a[108:109], v[124:127]
    v_mfma_f32_4x4x4_16b_bf16 v[128:131], a[110:111], a[110:111], v[128:131]
    s_waitcnt vmcnt(6)
    ds_read_b128 a[128:131], v20 offset:0
    ds_read_b128 a[132:135], v21 offset:0
    ds_read_b128 a[136:139], v22 offset:0
    ds_read_b128 a[140:143], v23 offset:0
    s_waitcnt lgkmcnt(4)
    v_mfma_f32_16x16x32_bf16 v[112:115], a[220:223], a[112:115], v[112:115]
    v_mfma_f32_4x4x4_16b_bf16 v[116:119], a[112:113], a[112:113], v[116:119]
    v_mfma_f32_4x4x4_16b_bf16 v[120:123], a[114:115], a[114:115], v[120:123]
    v_mfma_f32_16x16x32_bf16 v[112:115], a[220:223], a[116:119], v[112:115]
    v_mfma_f32_4x4x4_16b_bf16 v[124:127], a[116:117], a[116:117], v[124:127]
    v_mfma_f32_4x4x4_16b_bf16 v[128:131], a[118:119], a[118:119], v[128:131]
    v_mfma_f32_16x16x32_bf16 v[112:115], a[220:223], a[120:123], v[112:115]
    v_mfma_f32_4x4x4_16b_bf16 v[116:119], a[120:121], a[120:121], v[116:119]
    v_mfma_f32_4x4x4_16b_bf16 v[120:123], a[122:123], a[122:123], v[120:123]
    v_mfma_f32_16x16x32_bf16 v[112:115], a[220:223], a[124:127], v[112:115]
    v_mfma_f32_4x4x4_16b_bf16 v[124:127], a[124:125], a[124:125], v[124:127]
    v_mfma_f32_4x4x4_16b_bf16 v[128:131], a[126:127], a[126:127], v[128:131]
    s_cmp_lg_u32 s3, 0
    s_cbranch_scc1 L_polled_15
    s_waitcnt vmcnt(5)
    v_cmp_gt_u32 s[0:1], 1, v8
    s_mov_b32 s94, 0
    s_cmp_eq_u64 s[0:1], 0
    s_cbranch_scc1 L_polled_15
L_poll_14:
    s_add_u32 s94, s94, 1
    buffer_load_dword v8, v9, s[16:19], s15 offen sc1
    s_cmp_gt_u32 s94, 0x40000
    s_cbranch_scc1 L_polled_15
    s_waitcnt vmcnt(0)
    v_cmp_gt_u32 s[0:1], 1, v8
    s_nop 0
    s_cmp_eq_u64 s[0:1], 0
    s_cbranch_scc0 L_poll_14
L_polled_15:
    s_waitcnt lgkmcnt(0)
    s_barrier
    s_add_u32 m0, s61, 0
    s_add_u32 s58, s62, 0
    buffer_load_dwordx4 v1, s[16:19], s58 offen sc1 lds
    s_add_u32 m0, s61, 4096
    s_add_u32 s58, s62, 4096
    buffer_load_dwordx4 v1, s[16:19], s58 offen sc1 lds
    s_add_u32 m0, s61, 8192
    s_add_u32 s58, s62, 16384
    buffer_load_dwordx4 v1, s[16:19], s58 offen sc1 lds
    s_waitcnt vmcnt(3)
    ds_read_b128 a[144:147], v20 offset:16384
    ds_read_b128 a[148:151], v21 offset:16384
    ds_read_b128 a[152:155], v22 offset:16384
    ds_read_b128 a[156:159], v23 offset:16384
    v_mfma_f32_16x16x32_bf16 v[112:115], a[220:223], a[128:131], v[112:115]
    v_mfma_f32_4x4x4_16b_bf16 v[116:119], a[128:129], a[128:129], v[116:119]
    v_mfma_f32_4x4x4_16b_bf16 v[120:123], a[130:131], a[130:131], v[120:123]
    buffer_load_dwordx4 v[40:43], v19, s[16:19], s14 offen sc1
    v_add_u32 v19, 4096, v19
    v_mfma_f32_16x16x32_bf16 v[112:115], a[220:223], a[132:135], v[112:115]
    v_mfma_f32_4x4x4_16b_bf16 v[124:127], a[132:133], a[132:133], v[124:127]
    v_mfma_f32_4x4x4_16b_bf16 v[128:131], a[134:135], a[134:135], v[128:131]
    buffer_load_dwordx4 v[44:47], v19, s[16:19], s14 offen sc1
    v_mfma_f32_16x16x32_bf16 v[112:115], a[220:223], a[136:139], v[112:115]
    v_mfma_f32_4x4x4_16b_bf16 v[116:119], a[136:137], a[136:137], v[116:119]
    v_mfma_f32_4x4x4_16b_bf16 v[120:123], a[138:139], a[138:139], v[120:123]
    s_add_u32 m0, s61, 12288
    s_add_u32 s58, s62, 20480
    buffer_load_dwordx4 v1, s[16:19], s58 offen sc1 lds
    v_mfma_f32_16x16x32_bf16 v[112:115], a[220:223], a[140:143], v[112:115]
    v_mfma_f32_4x4x4_16b_bf16 v[124:127], a[140:141], a[140:141], v[124:127]
    v_mfma_f32_4x4x4_16b_bf16 v[128:131], a[142:143], a[142:143], v[128:131]
    s_add_u32 m0, s61, 16384
    s_add_u32 s58, s62, 32768
    buffer_load_dwordx4 v1, s[16:19], s58 offen sc1 lds
    s_add_u32 m0, s61, 20480
    s_add_u32 s58, s62, 36864
    buffer_load_dwordx4 v1, s[16:19], s58 offen sc1 lds
    s_waitcnt lgkmcnt(3)
    v_mfma_f32_16x16x32_bf16 v[112:115], a[220:223], a[144:147], v[112:115]
    v_mfma_f32_4x4x4_16b_bf16 v[116:119], a[144:145], a[144:145], v[116:119]
    v_mfma_f32_4x4x4_16b_bf16 v[120:123], a[146:147], a[146:147], v[120:123]
    s_waitcnt lgkmcnt(2)
    v_mfma_f32_16x16x32_bf16 v[112:115], a[220:223], a[148:151], v[112:115]
    v_mfma_f32_4x4x4_16b_bf16 v[124:127], a[148:149], a[148:149], v[124:127]
    v_mfma_f32_4x4x4_16b_bf16 v[128:131], a[150:151], a[150:151], v[128:131]
    s_waitcnt lgkmcnt(1)
    v_mfma_f32_16x16x32_bf16 v[112:115], a[220:223], a[152:155], v[112:115]
    v_mfma_f32_4x4x4_16b_bf16 v[116:119], a[152:153], a[152:153], v[116:119]
    v_mfma_f32_4x4x4_16b_bf16 v[120:123], a[154:155], a[154:155], v[120:123]
    s_waitcnt lgkmcnt(0)
    v_mfma_f32_16x16x32_bf16 v[112:115], a[220:223], a[156:159], v[112:115]
    v_mfma_f32_4x4x4_16b_bf16 v[124:127], a[156:157], a[156:157], v[124:127]
    v_mfma_f32_4x4x4_16b_bf16 v[128:131], a[158:159], a[158:159], v[128:131]
    s_mov_b32 s28, 0xffff0000
    s_mov_b32 s29, s28
    s_nop 3
    v_cndmask_b32 v32, v112, v113, s[28:29]
    s_mov_b32 s28, 0xaaaaaaaa
    s_mov_b32 s29, s28
    s_mov_b32 s30, 0xcccccccc
    s_mov_b32 s31, s30
    v_add_f32 v116, v116, v124
    v_add_f32 v117, v117, v125
    v_add_f32 v118, v118, v126
    v_add_f32 v119, v119, v127
    v_add_f32 v120, v120, v128
    v_add_f32 v121, v121, v129
    v_add_f32 v122, v122, v130
    v_add_f32 v123, v123, v131
    v_add_f32 v116, v116, v120
    v_add_f32 v117, v117, v121
    v_add_f32 v118, v118, v122
    v_add_f32 v119, v119, v123
    v_cndmask_b32 v116, v116, v117, s[28:29]
    v_cndmask_b32 v118, v118, v119, s[28:29]
    v_cndmask_b32 v34, v116, v118, s[30:31]
    v_mov_b32 v35, v34
    s_nop 1
    v_permlane32_swap_b32 v34, v35
    v_add_f32 v34, v34, v35
    v_mul_f32 v32, 0x3acccccd, v32
    v_mul_f32 v34, 0x3acccccd, v34
    v_fma_f32 v34, -v32, v32, v34
    v_max_f32 v34, 0, v34
    v_add_f32 v34, 0x3727c5ac, v34
    v_rsq_f32 v33, v34
    s_nop 0
    v_mul_f32_e64 v34, -v32, v33
    v_mov_b32 v32, v33
    s_waitcnt vmcnt(5)
    s_barrier
    ds_read_b128 a[184:187], v1 offset:0
    ds_read_b128 a[192:195], v1 offset:2048
    ds_read_b128 a[188:191], v1 offset:1024
    ds_read_b128 a[196:199], v1 offset:3072
    ds_read_b128 a[204:207], v1 offset:5120
    ds_read_b128 a[200:203], v1 offset:4096
    v_mov_b32 v8, 2
    s_movk_i32 s0, 0x2000
    buffer_store_dword v8, v2, s[16:19], 0 offen sc1
    buffer_store_dword v8, v2, s[16:19], s0 offen sc1
    s_waitcnt lgkmcnt(3)
    v_mfma_f32_32x32x16_bf16 v[64:79], a[184:187], a[0:3], 0
    ds_read_b128 a[208:211], v1 offset:6144
    s_waitcnt vmcnt(5)
    v_add_f32 v40, v40, v44
    v_mfma_f32_32x32x16_bf16 v[96:111], a[192:195], a[0:3], 0
    ds_read_b128 a[216:219], v1 offset:8192
    s_add_u32 m0, s61, 24576
    s_add_u32 s58, s62, 49152
    buffer_load_dwordx4 v1, s[16:19], s58 offen sc1 lds
    v_mfma_f32_32x32x16_bf16 v[80:95], a[188:191], a[0:3], 0
    ds_read_b128 a[212:215], v1 offset:7168
    v_add_f32 v41, v41, v45
    v_add_f32 v42, v42, v46
    s_waitcnt lgkmcnt(3)
    v_mfma_f32_32x32x16_bf16 v[64:79], a[196:199], a[4:7], v[64:79]
    ds_read_b128 a[184:187], v1 offset:9216
    s_add_u32 m0, s61, 28672
    s_add_u32 s58, s62, 53248
    buffer_load_dwordx4 v1, s[16:19], s58 offen sc1 lds
    v_mfma_f32_32x32x16_bf16 v[96:111], a[204:207], a[4:7], v[96:111]
    ds_read_b128 a[192:195], v1 offset:11264
    s_add_u32 m0, s61, 32768
    s_add_u32 s58, s62, 65536
    buffer_load_dwordx4 v1, s[16:19], s58 offen sc1 lds
    v_mfma_f32_32x32x16_bf16 v[80:95], a[200:203], a[4:7], v[80:95]
    ds_read_b128 a[188:191], v1 offset:10240
    v_add_f32 v43, v43, v47
    v_add_f32_dpp v40, v40, v40 row_ror:8 row_mask:0xf bank_mask:0xf
    s_waitcnt vmcnt(5)
    s_barrier
    s_waitcnt lgkmcnt(3)
    v_mfma_f32_32x32x16_bf16 v[64:79], a[208:211], a[8:11], v[64:79]
    ds_read_b128 a[196:199], v1 offset:12288
    v_add_f32_dpp v41, v41, v41 row_ror:8 row_mask:0xf bank_mask:0xf
    v_add_f32_dpp v42, v42, v42 row_ror:8 row_mask:0xf bank_mask:0xf
    v_mfma_f32_32x32x16_bf16 v[96:111], a[216:219], a[8:11], v[96:111]
    ds_read_b128 a[204:207], v1 offset:14336
    s_add_u32 m0, s61, 36864
    s_add_u32 s58, s62, 69632
    buffer_load_dwordx4 v1, s[16:19], s58 offen sc1 lds
    v_mfma_f32_32x32x16_bf16 v[80:95], a[212:215], a[8:11], v[80:95]
    ds_read_b128 a[200:203], v1 offset:13312
    v_add_f32_dpp v43, v43, v43 row_ror:8 row_mask:0xf bank_mask:0xf
    v_mov_b32 v44, v40
    s_waitcnt lgkmcnt(3)
    v_mfma_f32_32x32x16_bf16 v[64:79], a[184:187], a[12:15], v[64:79]
    ds_read_b128 a[208:211], v1 offset:15360
    s_add_u32 m0, s61, 40960
    s_add_u32 s58, s62, 81920
    buffer_load_dwordx4 v1, s[16:19], s58 offen sc1 lds
    v_mfma_f32_32x32x16_bf16 v[96:111], a[192:195], a[12:15], v[96:111]
    ds_read_b128 a[216:219], v1 offset:17408
    s_add_u32 m0, s61, 45056
    s_add_u32 s58, s62, 86016
    buffer_load_dwordx4 v1, s[16:19], s58 offen sc1 lds
    v_mfma_f32_32x32x16_bf16 v[80:95], a[188:191], a[12:15], v[80:95]
    ds_read_b128 a[212:215], v1 offset:16384
    v_mov_b32 v45, v41
    v_mov_b32 v46, v42
    s_waitcnt lgkmcnt(3)
    v_mfma_f32_32x32x16_bf16 v[64:79], a[196:199], a[16:19], v[64:79]
    ds_read_b128 a[184:187], v1 offset:18432
    v_mov_b32 v47, v43
    v_permlane16_swap_b32 v40, v44
    v_mfma_f32_32x32x16_bf16 v[96:111], a[204:207], a[16:19], v[96:111]
    ds_read_b128 a[192:195], v1 offset:20480
    s_add_u32 m0, s42, 0
    s_movk_i32 s58, 0
    buffer_load_dwordx4 v14, s[8:11], s58 offen lds
    v_mfma_f32_32x32x16_bf16 v[80:95], a[200:203], a[16:19], v[80:95]
    ds_read_b128 a[188:191], v1 offset:19456
    v_permlane16_swap_b32 v41, v45
    v_permlane16_swap_b32 v42, v46
    s_waitcnt lgkmcnt(3)
    v_mfma_f32_32x32x16_bf16 v[64:79], a[208:211], a[20:23], v[64:79]
    ds_read_b128 a[196:199], v1 offset:21504
    s_add_u32 m0, s42, 1024
    s_movk_i32 s58, 7680
    buffer_load_dwordx4 v14, s[8:11], s58 offen lds
    v_mfma_f32_32x32x16_bf16 v[96:111], a[216:219], a[20:23], v[96:111]
    ds_read_b128 a[204:207], v1 offset:23552
    s_add_u32 m0, s42, 2048
    s_movk_i32 s58, 15360
    buffer_load_dwordx4 v15, s[8:11], s58 offen lds
    v_mfma_f32_32x32x16_bf16 v[80:95], a[212:215], a[20:23], v[80:95]
    ds_read_b128 a[200:203], v1 offset:22528
    v_permlane16_swap_b32 v43, v47
    v_add_f32 v40, v40, v44
    s_waitcnt vmcnt(6)
    s_barrier
    s_waitcnt lgkmcnt(3)
    v_mfma_f32_32x32x16_bf16 v[64:79], a[184:187], a[24:27], v[64:79]
    ds_read_b128 a[208:211], v1 offset:24576
    v_add_f32 v41, v41, v45
    v_add_f32 v42, v42, v46
    v_mfma_f32_32x32x16_bf16 v[96:111], a[192:195], a[24:27], v[96:111]
    ds_read_b128 a[216:219], v1 offset:26624
    s_add_u32 m0, s61, 0
    s_add_u32 s58, s62, 98304
    buffer_load_dwordx4 v1, s[16:19], s58 offen sc1 lds
    v_mfma_f32_32x32x16_bf16 v[80:95], a[188:191], a[24:27], v[80:95]
    ds_read_b128 a[212:215], v1 offset:25600
    v_add_f32 v43, v43, v47
    v_mov_b32 v44, v40
    s_waitcnt lgkmcnt(3)
    v_mfma_f32_32x32x16_bf16 v[64:79], a[196:199], a[28:31], v[64:79]
    ds_read_b128 a[184:187], v1 offset:27648
    s_add_u32 m0, s61, 4096
    s_add_u32 s58, s62, 102400
    buffer_load_dwordx4 v1, s[16:19], s58 offen sc1 lds
    v_mfma_f32_32x32x16_bf16 v[96:111], a[204:207], a[28:31], v[96:111]
    ds_read_b128 a[192:195], v1 offset:29696
    s_add_u32 m0, s61, 8192
    s_add_u32 s58, s62, 114688
    buffer_load_dwordx4 v1, s[16:19], s58 offen sc1 lds
    v_mfma_f32_32x32x16_bf16 v[80:95], a[200:203], a[28:31], v[80:95]
    ds_read_b128 a[188:191], v1 offset:28672
    v_mov_b32 v45, v41
    v_mov_b32 v46, v42
    s_waitcnt lgkmcnt(3)
    v_mfma_f32_32x32x16_bf16 v[64:79], a[208:211], a[32:35], v[64:79]
    ds_read_b128 a[196:199], v1 offset:30720
    v_mov_b32 v47, v43
    v_permlane32_swap_b32 v40, v44
    v_mfma_f32_32x32x16_bf16 v[96:111], a[216:219], a[32:35], v[96:111]
    ds_read_b128 a[204:207], v1 offset:32768
    s_mov_b32 s20, s44
    s_mov_b32 s21, s45
    s_mov_b32 s22, 3456
    s_mov_b32 s23, 0x20000
    s_mul_i32 s43, s7, 216
    s_add_u32 s22, s43, 216
    v_lshlrev_b32 v29, 2, v0
    s_add_u32 m0, s42, 3072
    s_nop 0
    buffer_load_dword v29, s[20:23], s43 offen lds
    v_mfma_f32_32x32x16_bf16 v[80:95], a[212:215], a[32:35], v[80:95]
    ds_read_b128 a[200:203], v1 offset:31744
    v_permlane32_swap_b32 v41, v45
    v_permlane32_swap_b32 v42, v46
    s_waitcnt lgkmcnt(3)
    v_mfma_f32_32x32x16_bf16 v[64:79], a[184:187], a[36:39], v[64:79]
    ds_read_b128 a[208:211], v1 offset:33792
    s_mov_b32 s20, s48
    s_mov_b32 s21, s49
    s_mov_b32 s22, 1280
    s_mov_b32 s23, 0x20000
    s_mul_i32 s43, s101, 160
    s_add_u32 s22, s43, 160
    v_lshlrev_b32 v29, 2, v0
    s_add_u32 m0, s42, 3328
    s_nop 0
    buffer_load_dword v29, s[20:23], s43 offen lds
    v_mfma_f32_32x32x16_bf16 v[96:111], a[192:195], a[36:39], v[96:111]
    ds_read_b128 a[216:219], v1 offset:35840
    s_add_u32 m0, s61, 114688
    s_add_u32 s58, s62, 245760
    buffer_load_dwordx4 v1, s[16:19], s58 offen sc1 lds
    v_mfma_f32_32x32x16_bf16 v[80:95], a[188:191], a[36:39], v[80:95]
    ds_read_b128 a[212:215], v1 offset:34816
    v_permlane32_swap_b32 v43, v47
    v_add_f32 v40, v40, v44
    s_waitcnt vmcnt(9)
    s_barrier
    s_waitcnt lgkmcnt(3)
    v_mfma_f32_32x32x16_bf16 v[64:79], a[196:199], a[40:43], v[64:79]
    ds_read_b128 a[184:187], v1 offset:36864
    v_add_f32 v41, v41, v45
    v_add_f32 v42, v42, v46
    v_mfma_f32_32x32x16_bf16 v[96:111], a[204:207], a[40:43], v[96:111]
    ds_read_b128 a[192:195], v1 offset:38912
    s_add_u32 m0, s61, 12288
    s_add_u32 s58, s62, 118784
    buffer_load_dwordx4 v1, s[16:19], s58 offen sc1 lds
    v_mfma_f32_32x32x16_bf16 v[80:95], a[200:203], a[40:43], v[80:95]
    ds_read_b128 a[188:191], v1 offset:37888
    v_add_f32 v43, v43, v47
    ds_write_b128 v38, v[40:43]
    s_waitcnt lgkmcnt(4)
    v_mfma_f32_32x32x16_bf16 v[64:79], a[208:211], a[44:47], v[64:79]
    ds_read_b128 a[196:199], v1 offset:39936
    s_add_u32 m0, s61, 16384
    s_add_u32 s58, s62, 131072
    buffer_load_dwordx4 v1, s[16:19], s58 offen sc1 lds
    v_mfma_f32_32x32x16_bf16 v[96:111], a[216:219], a[44:47], v[96:111]
    ds_read_b128 a[204:207], v1 offset:41984
    s_add_u32 m0, s61, 20480
    s_add_u32 s58, s62, 135168
    buffer_load_dwordx4 v1, s[16:19], s58 offen sc1 lds
    v_mfma_f32_32x32x16_bf16 v[80:95], a[212:215], a[44:47], v[80:95]
    ds_read_b128 a[200:203], v1 offset:40960
    s_waitcnt lgkmcnt(4)
    v_mfma_f32_32x32x16_bf16 v[64:79], a[184:187], a[48:51], v[64:79]
    ds_read_b128 a[208:211], v1 offset:43008
    ds_read_b64_tr_b16 a[160:161], v238 offset:0
    ds_read_b64_tr_b16 a[162:163], v238 offset:160
    v_mfma_f32_32x32x16_bf16 v[96:111], a[192:195], a[48:51], v[96:111]
    ds_read_b128 a[216:219], v1 offset:45056
    s_add_u32 m0, s61, 118784
    s_add_u32 s58, s62, 249856
    buffer_load_dwordx4 v1, s[16:19], s58 offen sc1 lds
    v_mfma_f32_32x32x16_bf16 v[80:95], a[188:191], a[48:51], v[80:95]
    ds_read_b128 a[212:215], v1 offset:44032
    ds_read_b64_tr_b16 a[164:165], v238 offset:320
    ds_read_b64_tr_b16 a[166:167], v238 offset:480
    s_waitcnt lgkmcnt(7)
    v_mfma_f32_32x32x16_bf16 v[64:79], a[196:199], a[52:55], v[64:79]
    ds_read_b128 a[184:187], v1 offset:46080
    s_add_u32 m0, s61, 122880
    s_add_u32 s58, s62, 262144
    buffer_load_dwordx4 v1, s[16:19], s58 offen sc1 lds
    v_mfma_f32_32x32x16_bf16 v[96:111], a[204:207], a[52:55], v[96:111]
    ds_read_b128 a[192:195], v1 offset:48128
    s_add_u32 m0, s61, 126976
    s_add_u32 s58, s62, 266240
    buffer_load_dwordx4 v1, s[16:19], s58 offen sc1 lds
    v_mfma_f32_32x32x16_bf16 v[80:95], a[200:203], a[52:55], v[80:95]
    ds_read_b128 a[188:191], v1 offset:47104
    ds_read_b64_tr_b16 a[168:169], v238 offset:640
    ds_read_b64_tr_b16 a[172:173], v239 offset:32
    s_waitcnt vmcnt(9)
    s_barrier
    s_waitcnt lgkmcnt(7)
    v_mfma_f32_32x32x16_bf16 v[64:79], a[208:211], a[56:59], v[64:79]
    ds_read_b128 a[196:199], v1 offset:0
    ds_read_b64_tr_b16 a[174:175], v239 offset:192
    ds_read_b64_tr_b16 a[176:177], v239 offset:352
    v_mfma_f32_32x32x16_bf16 v[96:111], a[216:219], a[56:59], v[96:111]
    ds_read_b128 a[204:207], v1 offset:2048
    buffer_load_dword v8, v37, s[16:19], s15 offen sc1
    buffer_load_dword v31, v36, s[16:19], s15 offen sc1
    v_mfma_f32_32x32x16_bf16 v[80:95], a[212:215], a[56:59], v[80:95]
    ds_read_b128 a[200:203], v1 offset:1024
    ds_read_b64_tr_b16 a[178:179], v239 offset:512
    ds_read_b64_tr_b16 a[180:181], v239 offset:672
    s_waitcnt lgkmcnt(9)
    v_mfma_f32_32x32x16_bf16 v[64:79], a[184:187], a[60:63], v[64:79]
    ds_read_b128 a[208:211], v1 offset:3072
    s_add_u32 m0, s61, 24576
    s_add_u32 s58, s62, 147456
    buffer_load_dwordx4 v1, s[16:19], s58 offen sc1 lds
    v_mfma_f32_32x32x16_bf16 v[96:111], a[192:195], a[60:63], v[96:111]
    ds_read_b128 a[216:219], v1 offset:5120
    s_add_u32 m0, s61, 28672
    s_add_u32 s58, s62, 151552
    buffer_load_dwordx4 v1, s[16:19], s58 offen sc1 lds
    v_mfma_f32_32x32x16_bf16 v[80:95], a[188:191], a[60:63], v[80:95]
    ds_read_b128 a[212:215], v1 offset:4096
    ds_read_b128 a[228:231], v152
    ds_read_b128 a[232:235], v152 offset:16
    s_waitcnt lgkmcnt(7)
    v_mfma_f32_32x32x16_bf16 v[64:79], a[196:199], a[64:67], v[64:79]
    ds_read_b128 a[184:187], v1 offset:6144
    ds_read_b64 a[236:237], v153
    ds_read_b128 v[112:115], v39 offset:0
    v_mfma_f32_32x32x16_bf16 v[96:111], a[204:207], a[64:67], v[96:111]
    ds_read_b128 a[192:195], v1 offset:8192
    s_add_u32 m0, s61, 32768
    s_add_u32 s58, s62, 163840
    buffer_load_dwordx4 v1, s[16:19], s58 offen sc1 lds
    v_mfma_f32_32x32x16_bf16 v[80:95], a[200:203], a[64:67], v[80:95]
    ds_read_b128 a[188:191], v1 offset:7168
    ds_read_b128 v[116:119], v39 offset:32
    ds_read_b128 v[120:123], v39 offset:64
    s_waitcnt lgkmcnt(9)
    v_mfma_f32_32x32x16_bf16 v[64:79], a[208:211], a[68:71], v[64:79]
    ds_read_b128 a[196:199], v1 offset:9216
    s_add_u32 m0, s61, 131072
    s_add_u32 s58, s62, 278528
    buffer_load_dwordx4 v1, s[16:19], s58 offen sc1 lds
    v_mfma_f32_32x32x16_bf16 v[96:111], a[216:219], a[68:71], v[96:111]
    ds_read_b128 a[204:207], v1 offset:11264
    s_add_u32 m0, s61, 135168
    s_add_u32 s58, s62, 282624
    buffer_load_dwordx4 v1, s[16:19], s58 offen sc1 lds
    v_mfma_f32_32x32x16_bf16 v[80:95], a[212:215], a[68:71], v[80:95]
    ds_read_b128 a[200:203], v1 offset:10240
    ds_read_b128 v[124:127], v39 offset:96
    ds_read_b128 v[128:131], v39 offset:384
    s_waitcnt vmcnt(10)
    s_barrier
    s_waitcnt lgkmcnt(7)
    v_mfma_f32_32x32x16_bf16 v[64:79], a[184:187], a[72:75], v[64:79]
    ds_read_b128 a[208:211], v1 offset:12288
    ds_read_b128 v[132:135], v39 offset:128
    ds_read_b128 v[136:139], v39 offset:160
    v_mfma_f32_32x32x16_bf16 v[96:111], a[192:195], a[72:75], v[96:111]
    ds_read_b128 a[216:219], v1 offset:14336
    s_add_u32 m0, s61, 36864
    s_add_u32 s58, s62, 167936
    buffer_load_dwordx4 v1, s[16:19], s58 offen sc1 lds
    v_mfma_f32_32x32x16_bf16 v[80:95], a[188:191], a[72:75], v[80:95]
    ds_read_b128 a[212:215], v1 offset:13312
    ds_read_b128 v[140:143], v39 offset:192
    ds_read_b128 v[144:147], v39 offset:224
    s_waitcnt lgkmcnt(9)
    v_mfma_f32_32x32x16_bf16 v[64:79], a[196:199], a[76:79], v[64:79]
    ds_read_b128 a[184:187], v1 offset:15360
    s_add_u32 m0, s61, 40960
    s_add_u32 s58, s62, 180224
    buffer_load_dwordx4 v1, s[16:19], s58 offen sc1 lds
    v_mfma_f32_32x32x16_bf16 v[96:111], a[204:207], a[76:79], v[96:111]
    ds_read_b128 a[192:195], v1 offset:17408
    s_add_u32 m0, s61, 45056
    s_add_u32 s58, s62, 184320
    buffer_load_dwordx4 v1, s[16:19], s58 offen sc1 lds
    v_mfma_f32_32x32x16_bf16 v[80:95], a[200:203], a[76:79], v[80:95]
    ds_read_b128 a[188:191], v1 offset:16384
    ds_read_b128 v[148:151], v39 offset:416
    v_mul_f32 v112, v34, v112
    s_waitcnt lgkmcnt(6)
    v_mfma_f32_32x32x16_bf16 v[64:79], a[208:211], a[80:83], v[64:79]
    ds_read_b128 a[196:199], v1 offset:18432
    v_mul_f32 v113, v34, v113
    v_mul_f32 v114, v34, v114
    v_mfma_f32_32x32x16_bf16 v[96:111], a[216:219], a[80:83], v[96:111]
    ds_read_b128 a[204:207], v1 offset:20480
    s_add_u32 m0, s61, 139264
    s_add_u32 s58, s62, 294912
    buffer_load_dwordx4 v1, s[16:19], s58 offen sc1 lds
    v_mfma_f32_32x32x16_bf16 v[80:95], a[212:215], a[80:83], v[80:95]
    ds_read_b128 a[200:203], v1 offset:19456
    v_mul_f32 v115, v34, v115
    v_mul_f32 v116, v34, v116
    s_waitcnt lgkmcnt(4)
    v_mfma_f32_32x32x16_bf16 v[64:79], a[184:187], a[84:87], v[64:79]
    ds_read_b128 a[208:211], v1 offset:21504
    s_add_u32 m0, s61, 143360
    s_add_u32 s58, s62, 299008
    buffer_load_dwordx4 v1, s[16:19], s58 offen sc1 lds
    v_mfma_f32_32x32x16_bf16 v[96:111], a[192:195], a[84:87], v[96:111]
    ds_read_b128 a[216:219], v1 offset:23552
    s_add_u32 m0, s61, 147456
    s_add_u32 s58, s62, 311296
    buffer_load_dwordx4 v1, s[16:19], s58 offen sc1 lds
    v_mfma_f32_32x32x16_bf16 v[80:95], a[188:191], a[84:87], v[80:95]
    ds_read_b128 a[212:215], v1 offset:22528
    v_mul_f32 v117, v34, v117
    v_mul_f32 v118, v34, v118
    s_waitcnt vmcnt(8)
    s_cmp_lg_u32 s3, 0
    s_cbranch_scc1 L_pkok_16
    v_min_u32 v29, v8, v31
    v_cmp_gt_u32 s[0:1], 2, v29
    s_nop 0
    s_cmp_eq_u64 s[0:1], 0
    s_cbranch_scc0 L_pkok_16_s
L_pkok_16:
    s_barrier
    s_waitcnt lgkmcnt(3)
    v_mfma_f32_32x32x16_bf16 v[64:79], a[196:199], a[88:91], v[64:79]
    ds_read_b128 a[184:187], v1 offset:24576
    v_mul_f32 v119, v34, v119
    v_mul_f32 v120, v34, v120
    v_mfma_f32_32x32x16_bf16 v[96:111], a[204:207], a[88:91], v[96:111]
    ds_read_b128 a[192:195], v1 offset:26624
    s_add_u32 m0, s61, 0
    s_add_u32 s58, s62, 196608
    buffer_load_dwordx4 v1, s[16:19], s58 offen sc1 lds
    v_mfma_f32_32x32x16_bf16 v[80:95], a[200:203], a[88:91], v[80:95]
    ds_read_b128 a[188:191], v1 offset:25600
    v_mul_f32 v121, v34, v121
    v_mul_f32 v122, v34, v122
    s_waitcnt lgkmcnt(3)
    v_mfma_f32_32x32x16_bf16 v[64:79], a[208:211], a[92:95], v[64:79]
    ds_read_b128 a[196:199], v1 offset:27648
    s_add_u32 m0, s61, 4096
    s_add_u32 s58, s62, 200704
    buffer_load_dwordx4 v1, s[16:19], s58 offen sc1 lds
    v_mfma_f32_32x32x16_bf16 v[96:111], a[216:219], a[92:95], v[96:111]
    ds_read_b128 a[204:207], v1 offset:29696
    s_add_u32 m0, s61, 8192
    s_add_u32 s58, s62, 212992
    buffer_load_dwordx4 v1, s[16:19], s58 offen sc1 lds
    v_mfma_f32_32x32x16_bf16 v[80:95], a[212:215], a[92:95], v[80:95]
    ds_read_b128 a[200:203], v1 offset:28672
    v_mul_f32 v123, v34, v123
    v_mul_f32 v124, v34, v124
    s_waitcnt lgkmcnt(3)
    v_mfma_f32_32x32x16_bf16 v[64:79], a[184:187], a[96:99], v[64:79]
    ds_read_b128 a[208:211], v1 offset:30720
    v_mul_f32 v125, v34, v125
    v_mul_f32 v126, v34, v126
    v_mfma_f32_32x32x16_bf16 v[96:111], a[192:195], a[96:99], v[96:111]
    ds_read_b128 a[216:219], v1 offset:32768
    s_add_u32 m0, s61, 73728
    s_add_u32 s58, s41, 73728
    buffer_load_dwordx4 v1, s[16:19], s58 offen sc1 lds
    v_mfma_f32_32x32x16_bf16 v[80:95], a[188:191], a[96:99], v[80:95]
    ds_read_b128 a[212:215], v1 offset:31744
    v_mul_f32 v127, v34, v127
    v_mul_f32 v128, v34, v128
    s_waitcnt lgkmcnt(3)
    v_mfma_f32_32x32x16_bf16 v[64:79], a[196:199], a[100:103], v[64:79]
    ds_read_b128 a[184:187], v1 offset:33792
    buffer_load_dwordx4 v[156:159], v1, s[16:19], s56 offen offset:0 sc1
    v_mul_f32 v129, v34, v129
    v_mfma_f32_32x32x16_bf16 v[96:111], a[204:207], a[100:103], v[96:111]
    ds_read_b128 a[192:195], v1 offset:35840
    s_add_u32 m0, s61, 77824
    s_add_u32 s58, s41, 77824
    buffer_load_dwordx4 v1, s[16:19], s58 offen sc1 lds
    v_mfma_f32_32x32x16_bf16 v[80:95], a[200:203], a[100:103], v[80:95]
    ds_read_b128 a[188:191], v1 offset:34816
    v_mul_f32 v130, v34, v130
    v_mul_f32 v131, v34, v131
    s_waitcnt vmcnt(9)
    s_barrier
    s_waitcnt lgkmcnt(3)
    v_mfma_f32_32x32x16_bf16 v[64:79], a[208:211], a[104:107], v[64:79]
    ds_read_b128 a[196:199], v1 offset:36864
    v_mul_f32 v132, v34, v132
    v_mul_f32 v133, v34, v133
    v_mfma_f32_32x32x16_bf16 v[96:111], a[216:219], a[104:107], v[96:111]
    ds_read_b128 a[204:207], v1 offset:38912
    s_add_u32 m0, s61, 12288
    s_add_u32 s58, s62, 217088
    buffer_load_dwordx4 v1, s[16:19], s58 offen sc1 lds
    v_mfma_f32_32x32x16_bf16 v[80:95], a[212:215], a[104:107], v[80:95]
    ds_read_b128 a[200:203], v1 offset:37888
    v_mul_f32 v134, v34, v134
    v_mul_f32 v135, v34, v135
    s_waitcnt lgkmcnt(3)
    v_mfma_f32_32x32x16_bf16 v[64:79], a[184:187], a[108:111], v[64:79]
    ds_read_b128 a[208:211], v1 offset:39936
    s_add_u32 m0, s61, 16384
    s_add_u32 s58, s62, 229376
    buffer_load_dwordx4 v1, s[16:19], s58 offen sc1 lds
    v_mfma_f32_32x32x16_bf16 v[96:111], a[192:195], a[108:111], v[96:111]
    ds_read_b128 a[216:219], v1 offset:41984
    s_add_u32 m0, s61, 20480
    s_add_u32 s58, s62, 233472
    buffer_load_dwordx4 v1, s[16:19], s58 offen sc1 lds
    v_mfma_f32_32x32x16_bf16 v[80:95], a[188:191], a[108:111], v[80:95]
    ds_read_b128 a[212:215], v1 offset:40960
    v_mul_f32 v136, v34, v136
    v_mul_f32 v137, v34, v137
    s_waitcnt lgkmcnt(3)
    v_mfma_f32_32x32x16_bf16 v[64:79], a[196:199], a[112:115], v[64:79]
    ds_read_b128 a[184:187], v1 offset:43008
    v_mul_f32 v138, v34, v138
    v_mul_f32 v139, v34, v139
    v_mfma_f32_32x32x16_bf16 v[96:111], a[204:207], a[112:115], v[96:111]
    ds_read_b128 a[192:195], v1 offset:45056
    s_add_u32 m0, s61, 151552
    s_add_u32 s58, s62, 315392
    buffer_load_dwordx4 v1, s[16:19], s58 offen sc1 lds
    v_mfma_f32_32x32x16_bf16 v[80:95], a[200:203], a[112:115], v[80:95]
    ds_read_b128 a[188:191], v1 offset:44032
    v_mul_f32 v140, v34, v140
    v_mul_f32 v141, v34, v141
    s_waitcnt lgkmcnt(3)
    v_mfma_f32_32x32x16_bf16 v[64:79], a[208:211], a[116:119], v[64:79]
    ds_read_b128 a[196:199], v1 offset:46080
    buffer_load_dwordx4 v[160:163], v1, s[16:19], s56 offen offset:1024 sc1
    v_mul_f32 v142, v34, v142
    v_mfma_f32_32x32x16_bf16 v[96:111], a[216:219], a[116:119], v[96:111]
    ds_read_b128 a[204:207], v1 offset:48128
    s_add_u32 m0, s61, 49152
    s_add_u32 s58, s41, 49152
    buffer_load_dwordx4 v1, s[16:19], s58 offen sc1 lds
    v_mfma_f32_32x32x16_bf16 v[80:95], a[212:215], a[116:119], v[80:95]
    ds_read_b128 a[200:203], v1 offset:47104
    v_mul_f32 v143, v34, v143
    v_mul_f32 v144, v34, v144
    s_waitcnt vmcnt(9)
    s_barrier
    s_waitcnt lgkmcnt(3)
    v_mfma_f32_32x32x16_bf16 v[64:79], a[184:187], a[120:123], v[64:79]
    ds_read_b128 a[208:211], v1 offset:0
    v_mul_f32 v145, v34, v145
    v_mul_f32 v146, v34, v146
    v_mfma_f32_32x32x16_bf16 v[96:111], a[192:195], a[120:123], v[96:111]
    ds_read_b128 a[216:219], v1 offset:2048
    buffer_load_dwordx4 v[164:167], v1, s[16:19], s56 offen offset:2048 sc1
    v_mul_f32 v147, v34, v147
    v_mfma_f32_32x32x16_bf16 v[80:95], a[188:191], a[120:123], v[80:95]
    ds_read_b128 a[212:215], v1 offset:1024
    v_mul_f32 v148, v34, v148
    v_mul_f32 v149, v34, v149
    s_waitcnt lgkmcnt(3)
    v_mfma_f32_32x32x16_bf16 v[64:79], a[196:199], a[124:127], v[64:79]
    ds_read_b128 a[184:187], v1 offset:3072
    s_add_u32 m0, s61, 53248
    s_add_u32 s58, s41, 53248
    buffer_load_dwordx4 v1, s[16:19], s58 offen sc1 lds
    v_mfma_f32_32x32x16_bf16 v[96:111], a[204:207], a[124:127], v[96:111]
    ds_read_b128 a[192:195], v1 offset:5120
    buffer_load_dwordx4 v[168:171], v1, s[16:19], s56 offen offset:3072 sc1
    s_add_u32 s56, s56, 4096
    v_mfma_f32_32x32x16_bf16 v[80:95], a[200:203], a[124:127], v[80:95]
    ds_read_b128 a[188:191], v1 offset:4096
    v_mul_f32 v150, v34, v150
    v_mul_f32 v151, v34, v151
    s_waitcnt lgkmcnt(3)
    v_mfma_f32_32x32x16_bf16 v[64:79], a[208:211], a[128:131], v[64:79]
    ds_read_b128 a[196:199], v1 offset:6144
    v_mfma_f32_32x32x16_bf16 v[96:111], a[216:219], a[128:131], v[96:111]
    ds_read_b128 a[204:207], v1 offset:8192
    s_add_u32 m0, s61, 57344
    s_add_u32 s58, s41, 57344
    buffer_load_dwordx4 v1, s[16:19], s58 offen sc1 lds
    v_mfma_f32_32x32x16_bf16 v[80:95], a[212:215], a[128:131], v[80:95]
    ds_read_b128 a[200:203], v1 offset:7168
    s_waitcnt lgkmcnt(3)
    v_mfma_f32_32x32x16_bf16 v[64:79], a[184:187], a[132:135], v[64:79]
    ds_read_b128 a[208:211], v1 offset:9216
    buffer_load_dwordx4 v[172:175], v1, s[16:19], s56 offen offset:0 sc1
    v_mfma_f32_32x32x16_bf16 v[96:111], a[192:195], a[132:135], v[96:111]
    ds_read_b128 a[216:219], v1 offset:11264
    s_add_u32 m0, s61, 61440
    s_add_u32 s58, s41, 61440
    buffer_load_dwordx4 v1, s[16:19], s58 offen sc1 lds
    v_mfma_f32_32x32x16_bf16 v[80:95], a[188:191], a[132:135], v[80:95]
    ds_read_b128 a[212:215], v1 offset:10240
    s_waitcnt vmcnt(9)
    s_barrier
    s_waitcnt lgkmcnt(3)
    v_mfma_f32_32x32x16_bf16 v[64:79], a[196:199], a[136:139], v[64:79]
    ds_read_b128 a[184:187], v1 offset:12288
    v_mfma_f32_32x32x16_bf16 v[96:111], a[204:207], a[136:139], v[96:111]
    ds_read_b128 a[192:195], v1 offset:14336
    buffer_load_dwordx4 v[176:179], v1, s[16:19], s56 offen offset:1024 sc1
    v_mfma_f32_32x32x16_bf16 v[80:95], a[200:203], a[136:139], v[80:95]
    ds_read_b128 a[188:191], v1 offset:13312
    s_waitcnt lgkmcnt(3)
    v_mfma_f32_32x32x16_bf16 v[64:79], a[208:211], a[140:143], v[64:79]
    ds_read_b128 a[196:199], v1 offset:15360
    s_add_u32 m0, s61, 65536
    s_add_u32 s58, s41, 65536
    buffer_load_dwordx4 v1, s[16:19], s58 offen sc1 lds
    v_mfma_f32_32x32x16_bf16 v[96:111], a[216:219], a[140:143], v[96:111]
    ds_read_b128 a[204:207], v1 offset:17408
    buffer_load_dwordx4 v[180:183], v1, s[16:19], s56 offen offset:2048 sc1
    v_mfma_f32_32x32x16_bf16 v[80:95], a[212:215], a[140:143], v[80:95]
    ds_read_b128 a[200:203], v1 offset:16384
    s_waitcnt lgkmcnt(3)
    v_mfma_f32_32x32x16_bf16 v[64:79], a[184:187], a[144:147], v[64:79]
    ds_read_b128 a[208:211], v1 offset:18432
    v_mfma_f32_32x32x16_bf16 v[96:111], a[192:195], a[144:147], v[96:111]
    ds_read_b128 a[216:219], v1 offset:20480
    s_add_u32 m0, s61, 69632
    s_add_u32 s58, s41, 69632
    buffer_load_dwordx4 v1, s[16:19], s58 offen sc1 lds
    v_mfma_f32_32x32x16_bf16 v[80:95], a[188:191], a[144:147], v[80:95]
    ds_read_b128 a[212:215], v1 offset:19456
    s_waitcnt lgkmcnt(3)
    v_mfma_f32_32x32x16_bf16 v[64:79], a[196:199], a[148:151], v[64:79]
    ds_read_b128 a[184:187], v1 offset:21504
    buffer_load_dwordx4 v[184:187], v1, s[16:19], s56 offen offset:3072 sc1
    s_add_u32 s56, s56, 4096
    v_mfma_f32_32x32x16_bf16 v[96:111], a[204:207], a[148:151], v[96:111]
    ds_read_b128 a[192:195], v1 offset:23552
    buffer_load_dwordx4 v[188:191], v1, s[16:19], s56 offen offset:0 sc1
    v_mfma_f32_32x32x16_bf16 v[80:95], a[200:203], a[148:151], v[80:95]
    ds_read_b128 a[188:191], v1 offset:22528
    s_waitcnt lgkmcnt(3)
    v_mfma_f32_32x32x16_bf16 v[64:79], a[208:211], a[152:155], v[64:79]
    v_mfma_f32_32x32x16_bf16 v[96:111], a[216:219], a[152:155], v[96:111]
    buffer_load_dwordx4 v[192:195], v1, s[16:19], s56 offen offset:1024 sc1
    v_mfma_f32_32x32x16_bf16 v[80:95], a[212:215], a[152:155], v[80:95]
    s_waitcnt lgkmcnt(0)
    v_mfma_f32_32x32x16_bf16 v[64:79], a[184:187], a[156:159], v[64:79]
    buffer_load_dwordx4 v[196:199], v1, s[16:19], s56 offen offset:2048 sc1
    v_mfma_f32_32x32x16_bf16 v[96:111], a[192:195], a[156:159], v[96:111]
    buffer_load_dwordx4 v[200:203], v1, s[16:19], s56 offen offset:3072 sc1
    s_add_u32 s56, s56, 4096
    v_mfma_f32_32x32x16_bf16 v[80:95], a[188:191], a[156:159], v[80:95]
L_c1:
    s_barrier
    s_add_u32 m0, s61, 0
    s_add_u32 s58, s41, 0
    buffer_load_dwordx4 v1, s[16:19], s58 offen sc1 lds
    buffer_load_dwordx4 v[204:207], v1, s[16:19], s56 offen offset:0 sc1
    s_add_u32 m0, s61, 4096
    s_add_u32 s58, s41, 4096
    buffer_load_dwordx4 v1, s[16:19], s58 offen sc1 lds
    buffer_load_dwordx4 v[208:211], v1, s[16:19], s56 offen offset:1024 sc1
    v_pk_fma_f32 v[64:65], v[64:65], v[32:33], v[112:113] op_sel_hi:[1,0,1]
    v_pk_fma_f32 v[66:67], v[66:67], v[32:33], v[114:115] op_sel_hi:[1,0,1]
    v_pk_fma_f32 v[68:69], v[68:69], v[32:33], v[116:117] op_sel_hi:[1,0,1]
    v_pk_fma_f32 v[70:71], v[70:71], v[32:33], v[118:119] op_sel_hi:[1,0,1]
    v_pk_fma_f32 v[72:73], v[72:73], v[32:33], v[120:121] op_sel_hi:[1,0,1]
    v_pk_fma_f32 v[74:75], v[74:75], v[32:33], v[122:123] op_sel_hi:[1,0,1]
    v_pk_fma_f32 v[76:77], v[76:77], v[32:33], v[124:125] op_sel_hi:[1,0,1]
    v_pk_fma_f32 v[78:79], v[78:79], v[32:33], v[126:127] op_sel_hi:[1,0,1]
    v_pk_fma_f32 v[96:97], v[96:97], v[32:33], v[128:129] op_sel_hi:[1,0,1]
    v_pk_fma_f32 v[98:99], v[98:99], v[32:33], v[130:131] op_sel_hi:[1,0,1]
    v_cvt_pk_bf16_f32 v40, v64, v65
    v_cvt_pk_bf16_f32 v41, v66, v67
    v_cvt_pk_bf16_f32 v42, v68, v69
    v_cvt_pk_bf16_f32 v43, v70, v71
    v_cvt_pk_bf16_f32 v44, v72, v73
    v_cvt_pk_bf16_f32 v45, v74, v75
    v_cvt_pk_bf16_f32 v46, v76, v77
    v_cvt_pk_bf16_f32 v47, v78, v79
    v_cvt_pk_bf16_f32 v48, v96, v97
    v_cvt_pk_bf16_f32 v49, v98, v99
    v_mfma_f32_32x32x16_bf16 v[64:79], a[160:163], v[40:43], 0
    v_fma_f32 v80, v80, v32, v132
    v_fma_f32 v81, v81, v32, v133
    v_cvt_pk_bf16_f32 v52, v80, v81
    v_fma_f32 v82, v82, v32, v134
    v_fma_f32 v83, v83, v32, v135
    v_mfma_f32_32x32x16_bf16 v[112:127], a[172:175], v[40:43], 0
    v_cvt_pk_bf16_f32 v53, v82, v83
    v_fma_f32 v84, v84, v32, v136
    v_fma_f32 v85, v85, v32, v137
    v_cvt_pk_bf16_f32 v54, v84, v85
    v_fma_f32 v86, v86, v32, v138
    v_mfma_f32_32x32x16_bf16 v[64:79], a[164:167], v[44:47], v[64:79]
    v_fma_f32 v87, v87, v32, v139
    v_cvt_pk_bf16_f32 v55, v86, v87
    ds_write_b128 v245, v[52:55]
    v_fma_f32 v88, v88, v32, v140
    v_fma_f32 v89, v89, v32, v141
    v_mfma_f32_32x32x16_bf16 v[112:127], a[176:179], v[44:47], v[112:127]
    v_cvt_pk_bf16_f32 v56, v88, v89
    v_fma_f32 v90, v90, v32, v142
    v_fma_f32 v91, v91, v32, v143
    v_cvt_pk_bf16_f32 v57, v90, v91
    v_fma_f32 v92, v92, v32, v144
    v_mfma_f32_32x32x16_bf16 v[64:79], a[168:171], v[48:51], v[64:79]
    v_fma_f32 v93, v93, v32, v145
    v_cvt_pk_bf16_f32 v58, v92, v93
    v_fma_f32 v94, v94, v32, v146
    v_fma_f32 v95, v95, v32, v147
    v_cvt_pk_bf16_f32 v59, v94, v95
    v_mfma_f32_32x32x16_bf16 v[112:127], a[180:183], v[48:51], v[112:127]
    ds_write_b128 v246, v[56:59]
    v_fma_f32 v100, v100, v32, v148
    v_fma_f32 v101, v101, v32, v149
    v_cvt_pk_bf16_f32 v60, v100, v101
    v_fma_f32 v102, v102, v32, v150
    v_fma_f32 v103, v103, v32, v151
    v_cvt_pk_bf16_f32 v61, v102, v103
    ds_write_b128 v247, v[60:63]
    v_max3_f32 v4, v64, v65, v66
    v_min3_f32 v6, v64, v65, v66
    v_max3_f32 v4, v4, v67, v68
    v_min3_f32 v6, v6, v67, v68
    v_max3_f32 v4, v4, v69, v70
    v_min3_f32 v6, v6, v69, v70
    v_max3_f32 v4, v4, v71, v72
    v_min3_f32 v6, v6, v71, v72
    v_max3_f32 v4, v4, v73, v74
    v_min3_f32 v6, v6, v73, v74
    v_max3_f32 v4, v4, v75, v76
    s_add_u32 m0, s61, 8192
    s_add_u32 s58, s41, 8192
    buffer_load_dwordx4 v1, s[16:19], s58 offen sc1 lds
    v_min3_f32 v6, v6, v75, v76
    v_max3_f32 v4, v4, v77, v78
    v_min3_f32 v6, v6, v77, v78
    v_max3_f32 v4, v4, v79, v112
    v_min3_f32 v6, v6, v79, v112
    v_max3_f32 v4, v4, v113, v114
    v_min3_f32 v6, v6, v113, v114
    v_max_f32 v4, v4, v115
    v_min_f32 v6, v6, v115
    v_mul_f32 v4, s96, v4
    v_mul_f32 v6, s96, v6
    buffer_load_dwordx4 v[212:215], v1, s[16:19], s56 offen offset:2048 sc1
    v_pk_fma_f32 v[80:81], v[64:65], s[96:97], v[4:5] op_sel_hi:[1,1,0] neg_lo:[0,0,1] neg_hi:[0,0,1]
    v_pk_fma_f32 v[100:101], v[64:65], s[96:97], v[6:7] op_sel_hi:[1,1,0] neg_lo:[1,0,0] neg_hi:[1,0,0]
    v_pk_fma_f32 v[82:83], v[66:67], s[96:97], v[4:5] op_sel_hi:[1,1,0] neg_lo:[0,0,1] neg_hi:[0,0,1]
    v_pk_fma_f32 v[102:103], v[66:67], s[96:97], v[6:7] op_sel_hi:[1,1,0] neg_lo:[1,0,0] neg_hi:[1,0,0]
    v_pk_fma_f32 v[84:85], v[68:69], s[96:97], v[4:5] op_sel_hi:[1,1,0] neg_lo:[0,0,1] neg_hi:[0,0,1]
    v_pk_fma_f32 v[128:129], v[68:69], s[96:97], v[6:7] op_sel_hi:[1,1,0] neg_lo:[1,0,0] neg_hi:[1,0,0]
    v_pk_fma_f32 v[86:87], v[70:71], s[96:97], v[4:5] op_sel_hi:[1,1,0] neg_lo:[0,0,1] neg_hi:[0,0,1]
    v_pk_fma_f32 v[130:131], v[70:71], s[96:97], v[6:7] op_sel_hi:[1,1,0] neg_lo:[1,0,0] neg_hi:[1,0,0]
    v_pk_fma_f32 v[88:89], v[72:73], s[96:97], v[4:5] op_sel_hi:[1,1,0] neg_lo:[0,0,1] neg_hi:[0,0,1]
    v_pk_fma_f32 v[132:133], v[72:73], s[96:97], v[6:7] op_sel_hi:[1,1,0] neg_lo:[1,0,0] neg_hi:[1,0,0]
    v_pk_fma_f32 v[90:91], v[74:75], s[96:97], v[4:5] op_sel_hi:[1,1,0] neg_lo:[0,0,1] neg_hi:[0,0,1]
    s_add_u32 m0, s61, 12288
    s_add_u32 s58, s41, 12288
    buffer_load_dwordx4 v1, s[16:19], s58 offen sc1 lds
    v_pk_fma_f32 v[134:135], v[74:75], s[96:97], v[6:7] op_sel_hi:[1,1,0] neg_lo:[1,0,0] neg_hi:[1,0,0]
    v_pk_fma_f32 v[92:93], v[76:77], s[96:97], v[4:5] op_sel_hi:[1,1,0] neg_lo:[0,0,1] neg_hi:[0,0,1]
    v_pk_fma_f32 v[136:137], v[76:77], s[96:97], v[6:7] op_sel_hi:[1,1,0] neg_lo:[1,0,0] neg_hi:[1,0,0]
    v_pk_fma_f32 v[94:95], v[78:79], s[96:97], v[4:5] op_sel_hi:[1,1,0] neg_lo:[0,0,1] neg_hi:[0,0,1]
    v_pk_fma_f32 v[138:139], v[78:79], s[96:97], v[6:7] op_sel_hi:[1,1,0] neg_lo:[1,0,0] neg_hi:[1,0,0]
    v_pk_fma_f32 v[96:97], v[112:113], s[96:97], v[4:5] op_sel_hi:[1,1,0] neg_lo:[0,0,1] neg_hi:[0,0,1]
    v_pk_fma_f32 v[140:141], v[112:113], s[96:97], v[6:7] op_sel_hi:[1,1,0] neg_lo:[1,0,0] neg_hi:[1,0,0]
    v_pk_fma_f32 v[98:99], v[114:115], s[96:97], v[4:5] op_sel_hi:[1,1,0] neg_lo:[0,0,1] neg_hi:[0,0,1]
    v_pk_fma_f32 v[142:143], v[114:115], s[96:97], v[6:7] op_sel_hi:[1,1,0] neg_lo:[1,0,0] neg_hi:[1,0,0]
    v_exp_f32 v80, v80
    buffer_load_dwordx4 v[216:219], v1, s[16:19], s56 offen offset:3072 sc1
    s_add_u32 s56, s56, 4096
    v_exp_f32 v81, v81
    v_exp_f32 v82, v82
    v_exp_f32 v83, v83
    v_exp_f32 v84, v84
    v_exp_f32 v85, v85
    v_exp_f32 v86, v86
    v_exp_f32 v87, v87
    s_add_u32 m0, s61, 16384
    s_add_u32 s58, s41, 16384
    buffer_load_dwordx4 v1, s[16:19], s58 offen sc1 lds
    v_exp_f32 v88, v88
    v_exp_f32 v89, v89
    v_exp_f32 v90, v90
    v_exp_f32 v91, v91
    v_exp_f32 v92, v92
    v_exp_f32 v93, v93
    v_exp_f32 v94, v94
    buffer_load_dwordx4 v[220:223], v1, s[16:19], s56 offen offset:0 sc1
    v_exp_f32 v95, v95
    v_exp_f32 v96, v96
    v_exp_f32 v97, v97
    v_exp_f32 v98, v98
    v_exp_f32 v99, v99
    v_pk_add_f32 v[4:5], v[80:81], v[82:83]
    v_pk_add_f32 v[4:5], v[4:5], v[84:85]
    v_pk_add_f32 v[4:5], v[4:5], v[86:87]
    s_add_u32 m0, s61, 20480
    s_add_u32 s58, s41, 20480
    buffer_load_dwordx4 v1, s[16:19], s58 offen sc1 lds
    v_pk_add_f32 v[4:5], v[4:5], v[88:89]
    v_pk_add_f32 v[4:5], v[4:5], v[90:91]
    v_pk_add_f32 v[4:5], v[4:5], v[92:93]
    v_pk_add_f32 v[4:5], v[4:5], v[94:95]
    v_pk_add_f32 v[4:5], v[4:5], v[96:97]
    v_pk_add_f32 v[4:5], v[4:5], v[98:99]
    v_add_f32 v4, v4, v5
    v_rcp_f32 v4, v4
    s_nop 0
    v_pk_mul_f32 v[80:81], v[80:81], v[4:5] op_sel_hi:[1,0]
    v_pk_mul_f32 v[82:83], v[82:83], v[4:5] op_sel_hi:[1,0]
    v_pk_mul_f32 v[84:85], v[84:85], v[4:5] op_sel_hi:[1,0]
    buffer_load_dwordx4 v[224:227], v1, s[16:19], s56 offen offset:1024 sc1
    v_pk_mul_f32 v[86:87], v[86:87], v[4:5] op_sel_hi:[1,0]
    v_cvt_pk_bf16_f32 v64, v80, v81
    v_cvt_pk_bf16_f32 v65, v82, v83
    v_cvt_pk_bf16_f32 v66, v84, v85
    v_cvt_pk_bf16_f32 v67, v86, v87
    ds_write_b128 v240, v[64:67]
    v_pk_mul_f32 v[88:89], v[88:89], v[4:5] op_sel_hi:[1,0]
    v_pk_mul_f32 v[90:91], v[90:91], v[4:5] op_sel_hi:[1,0]
    v_pk_mul_f32 v[92:93], v[92:93], v[4:5] op_sel_hi:[1,0]
    v_pk_mul_f32 v[94:95], v[94:95], v[4:5] op_sel_hi:[1,0]
    v_cvt_pk_bf16_f32 v68, v88, v89
    s_add_u32 m0, s61, 24576
    s_add_u32 s58, s41, 24576
    buffer_load_dwordx4 v1, s[16:19], s58 offen sc1 lds
    v_cvt_pk_bf16_f32 v69, v90, v91
    v_cvt_pk_bf16_f32 v70, v92, v93
    v_cvt_pk_bf16_f32 v71, v94, v95
    ds_write_b128 v241, v[68:71]
    v_exp_f32 v100, v100
    v_exp_f32 v101, v101
    v_exp_f32 v102, v102
    v_exp_f32 v103, v103
    buffer_load_dwordx4 v[228:231], v1, s[16:19], s56 offen offset:2048 sc1
    v_exp_f32 v128, v128
    v_exp_f32 v129, v129
    v_exp_f32 v130, v130
    v_exp_f32 v131, v131
    v_exp_f32 v132, v132
    v_exp_f32 v133, v133
    v_exp_f32 v134, v134
    s_add_u32 m0, s61, 28672
    s_add_u32 s58, s41, 28672
    buffer_load_dwordx4 v1, s[16:19], s58 offen sc1 lds
    v_exp_f32 v135, v135
    v_exp_f32 v136, v136
    v_exp_f32 v137, v137
    v_exp_f32 v138, v138
    v_exp_f32 v139, v139
    v_exp_f32 v140, v140
    v_exp_f32 v141, v141
    buffer_load_dwordx4 v[232:235], v1, s[16:19], s56 offen offset:3072 sc1
    s_add_u32 s56, s56, 4096
    v_exp_f32 v142, v142
    v_exp_f32 v143, v143
    v_pk_add_f32 v[6:7], v[100:101], v[102:103]
    v_pk_add_f32 v[6:7], v[6:7], v[128:129]
    v_pk_add_f32 v[6:7], v[6:7], v[130:131]
    v_pk_add_f32 v[6:7], v[6:7], v[132:133]
    v_pk_add_f32 v[6:7], v[6:7], v[134:135]
    v_pk_add_f32 v[6:7], v[6:7], v[136:137]
    v_pk_add_f32 v[6:7], v[6:7], v[138:139]
    v_pk_add_f32 v[6:7], v[6:7], v[140:141]
    s_add_u32 m0, s61, 32768
    s_add_u32 s58, s41, 32768
    buffer_load_dwordx4 v1, s[16:19], s58 offen sc1 lds
    v_pk_add_f32 v[6:7], v[6:7], v[142:143]
    v_add_f32 v6, v6, v7
    v_rcp_f32 v6, v6
    v_pk_mul_f32 v[96:97], v[96:97], v[4:5] op_sel_hi:[1,0]
    v_pk_mul_f32 v[98:99], v[98:99], v[4:5] op_sel_hi:[1,0]
    v_pk_mul_f32 v[100:101], v[100:101], v[6:7] op_sel_hi:[1,0]
    v_pk_mul_f32 v[102:103], v[102:103], v[6:7] op_sel_hi:[1,0]
    v_cvt_pk_bf16_f32 v72, v96, v97
    v_cvt_pk_bf16_f32 v73, v98, v99
    v_cvt_pk_bf16_f32 v74, v100, v101
    v_cvt_pk_bf16_f32 v75, v102, v103
    buffer_load_dwordx4 v[236:239], v1, s[16:19], s56 offen offset:0 sc1
    ds_write_b128 v242, v[72:75]
    v_pk_mul_f32 v[128:129], v[128:129], v[6:7] op_sel_hi:[1,0]
    v_pk_mul_f32 v[130:131], v[130:131], v[6:7] op_sel_hi:[1,0]
    v_pk_mul_f32 v[132:133], v[132:133], v[6:7] op_sel_hi:[1,0]
    v_pk_mul_f32 v[134:135], v[134:135], v[6:7] op_sel_hi:[1,0]
    v_cvt_pk_bf16_f32 v76, v128, v129
    v_cvt_pk_bf16_f32 v77, v130, v131
    v_cvt_pk_bf16_f32 v78, v132, v133
    v_cvt_pk_bf16_f32 v79, v134, v135
    ds_write_b128 v243, v[76:79]
    v_pk_mul_f32 v[136:137], v[136:137], v[6:7] op_sel_hi:[1,0]
    s_add_u32 m0, s61, 36864
    s_add_u32 s58, s41, 36864
    buffer_load_dwordx4 v1, s[16:19], s58 offen sc1 lds
    v_pk_mul_f32 v[138:139], v[138:139], v[6:7] op_sel_hi:[1,0]
    v_pk_mul_f32 v[140:141], v[140:141], v[6:7] op_sel_hi:[1,0]
    v_pk_mul_f32 v[142:143], v[142:143], v[6:7] op_sel_hi:[1,0]
    v_cvt_pk_bf16_f32 v112, v136, v137
    v_cvt_pk_bf16_f32 v113, v138, v139
    v_cvt_pk_bf16_f32 v114, v140, v141
    v_cvt_pk_bf16_f32 v115, v142, v143
    ds_write_b128 v244, v[112:115]
    s_add_u32 m0, s61, 40960
    s_add_u32 s58, s41, 40960
    buffer_load_dwordx4 v1, s[16:19], s58 offen sc1 lds
    s_waitcnt vmcnt(37)
    s_waitcnt lgkmcnt(0)
    s_barrier
    ds_read_b64_tr_b16 v[80:81], v248 offset:0
    ds_read_b64_tr_b16 v[82:83], v249 offset:512
    ds_read_b64_tr_b16 v[84:85], v250 offset:0
    ds_read_b64_tr_b16 v[86:87], v251 offset:512
    ds_read_b64_tr_b16 v[88:89], v248 offset:2048
    ds_read_b64_tr_b16 v[90:91], v249 offset:2560
    ds_read_b64_tr_b16 v[92:93], v250 offset:2048
    ds_read_b64_tr_b16 v[94:95], v251 offset:2560
    ds_read_b64_tr_b16 v[96:97], v248 offset:4096
    ds_read_b64_tr_b16 v[98:99], v249 offset:4608
    ds_read_b64_tr_b16 v[100:101], v250 offset:4096
    ds_read_b64_tr_b16 v[102:103], v251 offset:4608
    s_add_u32 m0, s61, 45056
    s_add_u32 s58, s41, 45056
    buffer_load_dwordx4 v1, s[16:19], s58 offen sc1 lds
    s_waitcnt lgkmcnt(8)
    v_mfma_f32_32x32x16_bf16 v[136:151], v[80:83], v[84:87], 0
    ds_read_b64_tr_b16 v[128:129], v248 offset:6144
    ds_read_b64_tr_b16 v[130:131], v249 offset:6656
    ds_read_b64_tr_b16 v[132:133], v250 offset:6144
    ds_read_b64_tr_b16 v[134:135], v251 offset:6656
    s_waitcnt lgkmcnt(8)
    v_mfma_f32_32x32x16_bf16 v[136:151], v[88:91], v[92:95], v[136:151]
    ds_read_b64_tr_b16 v[80:81], v248 offset:8192
    ds_read_b64_tr_b16 v[82:83], v249 offset:8704
    ds_read_b64_tr_b16 v[84:85], v250 offset:8192
    ds_read_b64_tr_b16 v[86:87], v251 offset:8704
    s_waitcnt lgkmcnt(8)
    v_mfma_f32_32x32x16_bf16 v[136:151], v[96:99], v[100:103], v[136:151]
    ds_read_b64_tr_b16 v[88:89], v248 offset:10240
    ds_read_b64_tr_b16 v[90:91], v249 offset:10752
    ds_read_b64_tr_b16 v[92:93], v250 offset:10240
    ds_read_b64_tr_b16 v[94:95], v251 offset:10752
    s_waitcnt lgkmcnt(8)
    v_mfma_f32_32x32x16_bf16 v[136:151], v[128:131], v[132:135], v[136:151]
    ds_read_b64_tr_b16 v[96:97], v248 offset:12288
    ds_read_b64_tr_b16 v[98:99], v249 offset:12800
    ds_read_b64_tr_b16 v[100:101], v250 offset:12288
    ds_read_b64_tr_b16 v[102:103], v251 offset:12800
    s_waitcnt lgkmcnt(8)
    v_mfma_f32_32x32x16_bf16 v[136:151], v[80:83], v[84:87], v[136:151]
    ds_read_b64_tr_b16 v[128:129], v248 offset:14336
    ds_read_b64_tr_b16 v[130:131], v249 offset:14848
    ds_read_b64_tr_b16 v[132:133], v250 offset:14336
    ds_read_b64_tr_b16 v[134:135], v251 offset:14848
    s_waitcnt lgkmcnt(8)
    v_mfma_f32_32x32x16_bf16 v[136:151], v[88:91], v[92:95], v[136:151]
    s_waitcnt lgkmcnt(4)
    v_mfma_f32_32x32x16_bf16 v[136:151], v[96:99], v[100:103], v[136:151]
    s_waitcnt lgkmcnt(0)
    v_mfma_f32_32x32x16_bf16 v[136:151], v[128:131], v[132:135], v[136:151]
    ds_read_b128 a[184:187], v30 offset:0
    ds_read_b128 a[188:191], v30 offset:1024
    ds_read_b128 a[192:195], v30 offset:2048
    ds_read_b128 a[196:199], v30 offset:3072
    ds_read_b128 a[200:203], v30 offset:4096
    ds_read_b128 a[204:207], v30 offset:5120
    s_waitcnt lgkmcnt(5)
    v_mfma_f32_32x32x16_bf16 v[64:79], a[184:187], a[0:3], 0
    ds_read_b128 a[208:211], v30 offset:6144
    s_waitcnt lgkmcnt(5)
    v_mfma_f32_32x32x16_bf16 v[64:79], a[188:191], a[4:7], v[64:79]
    ds_read_b128 a[212:215], v30 offset:7168
    v_cvt_pk_bf16_f32 v40, v136, v137
    v_cvt_pk_bf16_f32 v41, v138, v139
    v_cvt_pk_bf16_f32 v42, v140, v141
    v_cvt_pk_bf16_f32 v43, v142, v143
    buffer_store_dwordx4 v[40:43], v252, s[16:19], s14 offen sc1
    s_waitcnt lgkmcnt(5)
    v_mfma_f32_32x32x16_bf16 v[64:79], a[192:195], a[8:11], v[64:79]
    ds_read_b128 a[184:187], v30 offset:8192
    v_cvt_pk_bf16_f32 v44, v144, v145
    v_cvt_pk_bf16_f32 v45, v146, v147
    v_cvt_pk_bf16_f32 v46, v148, v149
    v_cvt_pk_bf16_f32 v47, v150, v151
    buffer_store_dwordx4 v[44:47], v253, s[16:19], s14 offen sc1
    s_waitcnt lgkmcnt(5)
    v_mfma_f32_32x32x16_bf16 v[64:79], a[196:199], a[12:15], v[64:79]
    ds_read_b128 a[188:191], v30 offset:9216
    ds_read_b128 v[80:83], v39 offset:256
    ds_read_b128 v[84:87], v39 offset:288
    ds_read_b128 v[88:91], v39 offset:320
    ds_read_b128 v[92:95], v39 offset:352
    s_waitcnt lgkmcnt(9)
    v_mfma_f32_32x32x16_bf16 v[64:79], a[200:203], a[16:19], v[64:79]
    ds_read_b128 a[192:195], v30 offset:10240
    ds_read_b128 v[96:99], v39 offset:448
    s_lshl_b32 s28, s3, 10
    v_add_u32 v24, s28, v1
    v_cmp_gt_u32 vcc, 3840, v24
    s_waitcnt lgkmcnt(10)
    v_mfma_f32_32x32x16_bf16 v[64:79], a[204:207], a[20:23], v[64:79]
    ds_read_b128 a[196:199], v30 offset:11264
    buffer_load_dwordx4 v[240:243], v1, s[16:19], s56 offen offset:1024 sc1
    s_waitcnt lgkmcnt(10)
    v_mfma_f32_32x32x16_bf16 v[64:79], a[208:211], a[24:27], v[64:79]
    ds_read_b128 a[200:203], v30 offset:12288
    v_add_u32 v10, 158208, v24
    v_cndmask_b32 v28, v3, v24, vcc
    s_add_u32 s29, s14, 327680
    v_add_u32 v28, s29, v28
    s_waitcnt lgkmcnt(10)
    v_mfma_f32_32x32x16_bf16 v[64:79], a[212:215], a[28:31], v[64:79]
    ds_read_b128 a[204:207], v30 offset:13312
    s_lshr_b32 s43, s4, 1
    s_lshl_b32 s43, s43, 14
    v_lshrrev_b32 v26, 5, v0
    v_bfe_u32 v24, v0, 2, 1
    s_waitcnt lgkmcnt(10)
    v_mfma_f32_32x32x16_bf16 v[64:79], a[184:187], a[32:35], v[64:79]
    ds_read_b128 a[208:211], v30 offset:14336
    buffer_load_dwordx4 v[244:247], v1, s[16:19], s56 offen offset:2048 sc1
    s_waitcnt lgkmcnt(10)
    v_mfma_f32_32x32x16_bf16 v[64:79], a[188:191], a[36:39], v[64:79]
    ds_read_b128 a[212:215], v30 offset:15360
    v_cmp_eq_u32 vcc, v24, v26
    v_bfe_u32 v24, v0, 3, 2
    v_cmp_gt_u32 s[30:31], 2, v24
    v_and_b32 v27, 3, v0
    s_waitcnt lgkmcnt(6)
    v_mfma_f32_32x32x16_bf16 v[64:79], a[192:195], a[40:43], v[64:79]
    ds_read_b128 a[184:187], v30 offset:16384
    buffer_load_dwordx4 v[248:251], v1, s[16:19], s56 offen offset:3072 sc1
    s_add_u32 s56, s56, 4096
    s_waitcnt lgkmcnt(5)
    v_mfma_f32_32x32x16_bf16 v[64:79], a[196:199], a[44:47], v[64:79]
    ds_read_b128 a[188:191], v30 offset:17408
    v_lshl_add_u32 v24, v24, 2, v27
    v_mul_u32_u24 v26, 1920, v26
    v_lshl_add_u32 v24, v24, 4, v26
    v_add_u32 v24, 158208, v24
    s_waitcnt lgkmcnt(5)
    v_mfma_f32_32x32x16_bf16 v[64:79], a[200:203], a[48:51], v[64:79]
    ds_read_b128 a[192:195], v30 offset:18432
    v_mov_b32 v27, 155648
    v_cndmask_b32 v11, v27, v24, vcc
    v_cndmask_b32 v12, v27, v11, s[30:31]
    v_bfe_u32 v24, v0, 4, 1
    s_waitcnt lgkmcnt(5)
    v_mfma_f32_32x32x16_bf16 v[64:79], a[204:207], a[52:55], v[64:79]
    ds_read_b128 a[196:199], v30 offset:19456
    buffer_load_dwordx4 v[252:255], v1, s[16:19], s56 offen offset:0 sc1
    s_waitcnt lgkmcnt(5)
    v_mfma_f32_32x32x16_bf16 v[64:79], a[208:211], a[56:59], v[64:79]
    ds_read_b128 a[200:203], v30 offset:20480
    v_lshlrev_b32 v24, 16, v24
    v_and_b32 v26, 15, v0
    v_lshl_add_u32 v24, v26, 4, v24
    s_lshl_b32 s30, s3, 17
    s_waitcnt lgkmcnt(5)
    v_mfma_f32_32x32x16_bf16 v[64:79], a[212:215], a[60:63], v[64:79]
    ds_read_b128 a[204:207], v30 offset:21504
    s_add_u32 s30, s30, s13
    s_lshr_b32 s31, s5, 2
    s_mul_i32 s31, s31, 17408
    s_add_u32 s30, s30, s31
    s_waitcnt lgkmcnt(5)
    v_mfma_f32_32x32x16_bf16 v[64:79], a[184:187], a[64:67], v[64:79]
    ds_read_b128 a[208:211], v30 offset:22528
    s_waitcnt lgkmcnt(5)
    v_mfma_f32_32x32x16_bf16 v[64:79], a[188:191], a[68:71], v[64:79]
    ds_read_b128 a[212:215], v30 offset:23552
    s_and_b32 s31, s5, 3
    s_mul_i32 s31, s31, 1280
    s_add_u32 s30, s30, s31
    v_add_u32 v24, s30, v24
    s_waitcnt lgkmcnt(5)
    v_mfma_f32_32x32x16_bf16 v[64:79], a[192:195], a[72:75], v[64:79]
    ds_read_b128 a[184:187], v30 offset:24576
    s_waitcnt lgkmcnt(5)
    v_mfma_f32_32x32x16_bf16 v[64:79], a[196:199], a[76:79], v[64:79]
    ds_read_b128 a[188:191], v30 offset:25600
    v_lshrrev_b32 v26, 5, v0
    v_mul_u32_u24 v26, 768, v26
    v_add_u32 v13, v24, v26
    v_cmp_gt_u32 vcc, 32, v0
    s_waitcnt vmcnt(4)
    v_mov_b32 v8, 3
    s_waitcnt lgkmcnt(0)
    s_barrier
    buffer_store_dword v8, v2, s[16:19], s15 offen sc1
    v_mfma_f32_32x32x16_bf16 v[64:79], a[200:203], a[80:83], v[64:79]
    ds_read_b128 a[192:195], v30 offset:26624
    v_cndmask_b32 v25, v3, v24, vcc
    v_mul_f32 v80, v34, v80
    v_mul_f32 v81, v34, v81
    v_mul_f32 v82, v34, v82
    v_mfma_f32_32x32x16_bf16 v[64:79], a[204:207], a[84:87], v[64:79]
    ds_read_b128 a[196:199], v30 offset:27648
    s_add_u32 m0, s61, 81920
    s_add_u32 s58, s41, 81920
    buffer_load_dwordx4 v1, s[16:19], s58 offen sc1 lds
    v_mfma_f32_32x32x16_bf16 v[64:79], a[208:211], a[88:91], v[64:79]
    ds_read_b128 a[200:203], v30 offset:28672
    v_mul_f32 v83, v34, v83
    v_mul_f32 v84, v34, v84
    v_mul_f32 v85, v34, v85
    v_mul_f32 v86, v34, v86
    v_mfma_f32_32x32x16_bf16 v[64:79], a[212:215], a[92:95], v[64:79]
    ds_read_b128 a[204:207], v30 offset:29696
    v_mul_f32 v87, v34, v87
    v_mul_f32 v88, v34, v88
    v_mul_f32 v89, v34, v89
    v_mul_f32 v90, v34, v90
    v_mfma_f32_32x32x16_bf16 v[64:79], a[184:187], a[96:99], v[64:79]
    ds_read_b128 a[208:211], v30 offset:30720
    s_add_u32 m0, s61, 86016
    s_add_u32 s58, s41, 86016
    buffer_load_dwordx4 v1, s[16:19], s58 offen sc1 lds
    v_mfma_f32_32x32x16_bf16 v[64:79], a[188:191], a[100:103], v[64:79]
    ds_read_b128 a[212:215], v30 offset:31744
    v_mul_f32 v91, v34, v91
    v_mul_f32 v92, v34, v92
    v_mul_f32 v93, v34, v93
    v_mul_f32 v94, v34, v94
    s_waitcnt lgkmcnt(5)
    v_mfma_f32_32x32x16_bf16 v[64:79], a[192:195], a[104:107], v[64:79]
    ds_read_b128 a[184:187], v30 offset:32768
    s_add_u32 m0, s61, 90112
    s_add_u32 s58, s41, 90112
    buffer_load_dwordx4 v1, s[16:19], s58 offen sc1 lds
    s_waitcnt lgkmcnt(5)
    v_mfma_f32_32x32x16_bf16 v[64:79], a[196:199], a[108:111], v[64:79]
    ds_read_b128 a[188:191], v30 offset:33792
    v_mul_f32 v95, v34, v95
    v_mul_f32 v96, v34, v96
    v_mul_f32 v97, v34, v97
    v_mul_f32 v98, v34, v98
    s_waitcnt lgkmcnt(5)
    v_mfma_f32_32x32x16_bf16 v[64:79], a[200:203], a[112:115], v[64:79]
    ds_read_b128 a[192:195], v30 offset:34816
    v_mul_f32 v99, v34, v99
    s_lshr_b32 s40, s101, 1
    s_lshl_b32 s40, s40, 22
    s_and_b32 s29, s101, 1
    s_waitcnt lgkmcnt(5)
    v_mfma_f32_32x32x16_bf16 v[64:79], a[204:207], a[116:119], v[64:79]
    ds_read_b128 a[196:199], v30 offset:35840
    s_add_u32 m0, s61, 94208
    s_add_u32 s58, s41, 94208
    buffer_load_dwordx4 v1, s[16:19], s58 offen sc1 lds
    s_waitcnt lgkmcnt(5)
    v_mfma_f32_32x32x16_bf16 v[64:79], a[208:211], a[120:123], v[64:79]
    ds_read_b128 a[200:203], v30 offset:36864
    s_lshl_b32 s29, s29, 20
    s_add_u32 s40, s40, s29
    s_mul_i32 s29, s57, 156672
    s_add_u32 s40, s40, s29
    s_waitcnt lgkmcnt(5)
    v_mfma_f32_32x32x16_bf16 v[64:79], a[212:215], a[124:127], v[64:79]
    ds_read_b128 a[204:207], v30 offset:37888
    s_add_u32 s40, s40, 109051904
    s_waitcnt lgkmcnt(5)
    v_mfma_f32_32x32x16_bf16 v[64:79], a[184:187], a[128:131], v[64:79]
    ds_read_b128 a[208:211], v30 offset:38912
    s_add_u32 m0, s61, 98304
    s_add_u32 s58, s41, 98304
    buffer_load_dwordx4 v1, s[16:19], s58 offen sc1 lds
    s_waitcnt lgkmcnt(5)
    v_mfma_f32_32x32x16_bf16 v[64:79], a[188:191], a[132:135], v[64:79]
    ds_read_b128 a[212:215], v30 offset:39936
    s_waitcnt lgkmcnt(5)
    v_mfma_f32_32x32x16_bf16 v[64:79], a[192:195], a[136:139], v[64:79]
    s_add_u32 m0, s61, 102400
    s_add_u32 s58, s41, 102400
    buffer_load_dwordx4 v1, s[16:19], s58 offen sc1 lds
    s_waitcnt lgkmcnt(4)
    v_mfma_f32_32x32x16_bf16 v[64:79], a[196:199], a[140:143], v[64:79]
    s_waitcnt lgkmcnt(3)
    v_mfma_f32_32x32x16_bf16 v[64:79], a[200:203], a[144:147], v[64:79]
    s_waitcnt lgkmcnt(2)
    v_mfma_f32_32x32x16_bf16 v[64:79], a[204:207], a[148:151], v[64:79]
    s_add_u32 m0, s61, 106496
    s_add_u32 s58, s41, 106496
    buffer_load_dwordx4 v1, s[16:19], s58 offen sc1 lds
    s_waitcnt lgkmcnt(1)
    v_mfma_f32_32x32x16_bf16 v[64:79], a[208:211], a[152:155], v[64:79]
    s_waitcnt lgkmcnt(0)
    v_mfma_f32_32x32x16_bf16 v[64:79], a[212:215], a[156:159], v[64:79]
    s_add_u32 m0, s61, 110592
    s_add_u32 s58, s41, 110592
    buffer_load_dwordx4 v1, s[16:19], s58 offen sc1 lds
    s_getpc_b64 s[30:31]
L_tc_17:
    s_lshr_b32 s28, s2, 3
    s_lshl_b32 s28, s28, 2
    s_add_u32 s28, s28, s3
    s_lshl_b32 s28, s28, 8
    s_add_u32 s28, s28, L_c2-L_tc_17
    v_lshrrev_b32 v29, 5, v0
    v_lshl_add_u32 v29, v29, 7, s28
    v_min_u32 v29, L_end-L_tc_17, v29
    global_load_dword v29, v29, s[30:31]
    v_pk_fma_f32 v[104:105], v[104:105], v[32:33], v[96:97] op_sel_hi:[1,0,1]
    v_pk_fma_f32 v[106:107], v[106:107], v[32:33], v[98:99] op_sel_hi:[1,0,1]
    v_pk_fma_f32 v[64:65], v[64:65], v[32:33], v[80:81] op_sel_hi:[1,0,1]
    v_pk_fma_f32 v[66:67], v[66:67], v[32:33], v[82:83] op_sel_hi:[1,0,1]
    v_pk_fma_f32 v[68:69], v[68:69], v[32:33], v[84:85] op_sel_hi:[1,0,1]
    v_pk_fma_f32 v[70:71], v[70:71], v[32:33], v[86:87] op_sel_hi:[1,0,1]
    v_pk_fma_f32 v[72:73], v[72:73], v[32:33], v[88:89] op_sel_hi:[1,0,1]
    v_pk_fma_f32 v[74:75], v[74:75], v[32:33], v[90:91] op_sel_hi:[1,0,1]
    v_pk_fma_f32 v[76:77], v[76:77], v[32:33], v[92:93] op_sel_hi:[1,0,1]
    v_pk_fma_f32 v[78:79], v[78:79], v[32:33], v[94:95] op_sel_hi:[1,0,1]
    v_cvt_pk_bf16_f32 v40, v64, v65
    v_cvt_pk_bf16_f32 v41, v66, v67
    v_cvt_pk_bf16_f32 v42, v68, v69
    v_cvt_pk_bf16_f32 v43, v70, v71
    v_cvt_pk_bf16_f32 v44, v72, v73
    v_cvt_pk_bf16_f32 v45, v74, v75
    v_cvt_pk_bf16_f32 v46, v76, v77
    v_cvt_pk_bf16_f32 v47, v78, v79
    v_cvt_pk_bf16_f32 v48, v104, v105
    v_cvt_pk_bf16_f32 v49, v106, v107
    v_mfma_f32_32x32x16_bf16 v[104:119], a[160:163], v[40:43], 0
    s_xor_b32 s28, s43, 0
    buffer_load_dwordx4 a[0:3], v28, s[16:19], s28 offen sc1
    v_mfma_f32_32x32x16_bf16 v[120:135], a[172:175], v[40:43], 0
    s_xor_b32 s28, s43, 4096
    buffer_load_dwordx4 a[4:7], v28, s[16:19], s28 offen sc1
    v_mfma_f32_32x32x16_bf16 v[104:119], a[164:167], v[44:47], v[104:119]
    s_xor_b32 s28, s43, 16384
    buffer_load_dwordx4 a[8:11], v28, s[16:19], s28 offen sc1
    v_mfma_f32_32x32x16_bf16 v[120:135], a[176:179], v[44:47], v[120:135]
    v_mfma_f32_32x32x16_bf16 v[104:119], a[168:171], v[48:51], v[104:119]
    v_mfma_f32_32x32x16_bf16 v[120:135], a[180:183], v[48:51], v[120:135]
    s_nop 10
    v_max3_f32 v4, v104, v105, v106
    v_min3_f32 v6, v104, v105, v106
    v_max3_f32 v4, v4, v107, v108
    v_min3_f32 v6, v6, v107, v108
    v_max3_f32 v4, v4, v109, v110
    v_min3_f32 v6, v6, v109, v110
    v_max3_f32 v4, v4, v111, v112
    v_min3_f32 v6, v6, v111, v112
    v_max3_f32 v4, v4, v113, v114
    s_xor_b32 s28, s43, 20480
    buffer_load_dwordx4 a[12:15], v28, s[16:19], s28 offen sc1
    v_min3_f32 v6, v6, v113, v114
    v_max3_f32 v4, v4, v115, v116
    v_min3_f32 v6, v6, v115, v116
    v_max3_f32 v4, v4, v117, v118
    v_min3_f32 v6, v6, v117, v118
    v_max3_f32 v4, v4, v119, v120
    v_min3_f32 v6, v6, v119, v120
    v_max3_f32 v4, v4, v121, v122
    v_min3_f32 v6, v6, v121, v122
    s_xor_b32 s28, s43, 32768
    buffer_load_dwordx4 a[16:19], v28, s[16:19], s28 offen sc1
    v_max_f32 v4, v4, v123
    v_min_f32 v6, v6, v123
    v_mul_f32 v4, s96, v4
    v_mul_f32 v6, s96, v6
    v_pk_fma_f32 v[64:65], v[104:105], s[96:97], v[4:5] op_sel_hi:[1,1,0] neg_lo:[0,0,1] neg_hi:[0,0,1]
    v_pk_fma_f32 v[84:85], v[104:105], s[96:97], v[6:7] op_sel_hi:[1,1,0] neg_lo:[1,0,0] neg_hi:[1,0,0]
    v_pk_fma_f32 v[66:67], v[106:107], s[96:97], v[4:5] op_sel_hi:[1,1,0] neg_lo:[0,0,1] neg_hi:[0,0,1]
    v_pk_fma_f32 v[86:87], v[106:107], s[96:97], v[6:7] op_sel_hi:[1,1,0] neg_lo:[1,0,0] neg_hi:[1,0,0]
    v_pk_fma_f32 v[68:69], v[108:109], s[96:97], v[4:5] op_sel_hi:[1,1,0] neg_lo:[0,0,1] neg_hi:[0,0,1]
    s_xor_b32 s28, s43, 36864
    buffer_load_dwordx4 a[20:23], v28, s[16:19], s28 offen sc1
    v_pk_fma_f32 v[88:89], v[108:109], s[96:97], v[6:7] op_sel_hi:[1,1,0] neg_lo:[1,0,0] neg_hi:[1,0,0]
    v_pk_fma_f32 v[70:71], v[110:111], s[96:97], v[4:5] op_sel_hi:[1,1,0] neg_lo:[0,0,1] neg_hi:[0,0,1]
    v_pk_fma_f32 v[90:91], v[110:111], s[96:97], v[6:7] op_sel_hi:[1,1,0] neg_lo:[1,0,0] neg_hi:[1,0,0]
    v_pk_fma_f32 v[72:73], v[112:113], s[96:97], v[4:5] op_sel_hi:[1,1,0] neg_lo:[0,0,1] neg_hi:[0,0,1]
    v_pk_fma_f32 v[92:93], v[112:113], s[96:97], v[6:7] op_sel_hi:[1,1,0] neg_lo:[1,0,0] neg_hi:[1,0,0]
    v_pk_fma_f32 v[74:75], v[114:115], s[96:97], v[4:5] op_sel_hi:[1,1,0] neg_lo:[0,0,1] neg_hi:[0,0,1]
    v_pk_fma_f32 v[94:95], v[114:115], s[96:97], v[6:7] op_sel_hi:[1,1,0] neg_lo:[1,0,0] neg_hi:[1,0,0]
    v_pk_fma_f32 v[76:77], v[116:117], s[96:97], v[4:5] op_sel_hi:[1,1,0] neg_lo:[0,0,1] neg_hi:[0,0,1]
    v_pk_fma_f32 v[96:97], v[116:117], s[96:97], v[6:7] op_sel_hi:[1,1,0] neg_lo:[1,0,0] neg_hi:[1,0,0]
    s_xor_b32 s28, s43, 49152
    buffer_load_dwordx4 a[24:27], v28, s[16:19], s28 offen sc1
    v_pk_fma_f32 v[78:79], v[118:119], s[96:97], v[4:5] op_sel_hi:[1,1,0] neg_lo:[0,0,1] neg_hi:[0,0,1]
    v_pk_fma_f32 v[98:99], v[118:119], s[96:97], v[6:7] op_sel_hi:[1,1,0] neg_lo:[1,0,0] neg_hi:[1,0,0]
    v_pk_fma_f32 v[80:81], v[120:121], s[96:97], v[4:5] op_sel_hi:[1,1,0] neg_lo:[0,0,1] neg_hi:[0,0,1]
    v_pk_fma_f32 v[100:101], v[120:121], s[96:97], v[6:7] op_sel_hi:[1,1,0] neg_lo:[1,0,0] neg_hi:[1,0,0]
    v_pk_fma_f32 v[82:83], v[122:123], s[96:97], v[4:5] op_sel_hi:[1,1,0] neg_lo:[0,0,1] neg_hi:[0,0,1]
    v_pk_fma_f32 v[102:103], v[122:123], s[96:97], v[6:7] op_sel_hi:[1,1,0] neg_lo:[1,0,0] neg_hi:[1,0,0]
    v_exp_f32 v64, v64
    v_exp_f32 v65, v65
    s_xor_b32 s28, s43, 53248
    buffer_load_dwordx4 a[28:31], v28, s[16:19], s28 offen sc1
    v_exp_f32 v66, v66
    v_exp_f32 v67, v67
    v_exp_f32 v68, v68
    v_exp_f32 v69, v69
    v_exp_f32 v70, v70
    v_exp_f32 v71, v71
    s_xor_b32 s28, s43, 65536
    buffer_load_dwordx4 a[32:35], v28, s[16:19], s28 offen sc1
    v_exp_f32 v72, v72
    v_exp_f32 v73, v73
    v_exp_f32 v74, v74
    v_exp_f32 v75, v75
    v_exp_f32 v76, v76
    v_exp_f32 v77, v77
    s_xor_b32 s28, s43, 69632
    buffer_load_dwordx4 a[36:39], v28, s[16:19], s28 offen sc1
    v_exp_f32 v78, v78
    v_exp_f32 v79, v79
    v_exp_f32 v80, v80
    v_exp_f32 v81, v81
    v_exp_f32 v82, v82
    v_exp_f32 v83, v83
    s_xor_b32 s28, s43, 81920
    buffer_load_dwordx4 a[40:43], v28, s[16:19], s28 offen sc1
    v_pk_add_f32 v[4:5], v[64:65], v[66:67]
    v_pk_add_f32 v[4:5], v[4:5], v[68:69]
    v_pk_add_f32 v[4:5], v[4:5], v[70:71]
    v_pk_add_f32 v[4:5], v[4:5], v[72:73]
    v_pk_add_f32 v[4:5], v[4:5], v[74:75]
    v_pk_add_f32 v[4:5], v[4:5], v[76:77]
    v_pk_add_f32 v[4:5], v[4:5], v[78:79]
    v_pk_add_f32 v[4:5], v[4:5], v[80:81]
    v_pk_add_f32 v[4:5], v[4:5], v[82:83]
    s_xor_b32 s28, s43, 86016
    buffer_load_dwordx4 a[44:47], v28, s[16:19], s28 offen sc1
    v_add_f32 v4, v4, v5
    v_rcp_f32 v4, v4
    s_nop 0
    v_pk_mul_f32 v[64:65], v[64:65], v[4:5] op_sel_hi:[1,0]
    v_pk_mul_f32 v[66:67], v[66:67], v[4:5] op_sel_hi:[1,0]
    v_pk_mul_f32 v[68:69], v[68:69], v[4:5] op_sel_hi:[1,0]
    v_pk_mul_f32 v[70:71], v[70:71], v[4:5] op_sel_hi:[1,0]
    v_cvt_pk_bf16_f32 v40, v64, v65
    v_cvt_pk_bf16_f32 v41, v66, v67
    v_cvt_pk_bf16_f32 v42, v68, v69
    s_xor_b32 s28, s43, 98304
    buffer_load_dwordx4 a[48:51], v28, s[16:19], s28 offen sc1
    v_cvt_pk_bf16_f32 v43, v70, v71
    v_pk_mul_f32 v[72:73], v[72:73], v[4:5] op_sel_hi:[1,0]
    v_pk_mul_f32 v[74:75], v[74:75], v[4:5] op_sel_hi:[1,0]
    v_pk_mul_f32 v[76:77], v[76:77], v[4:5] op_sel_hi:[1,0]
    v_pk_mul_f32 v[78:79], v[78:79], v[4:5] op_sel_hi:[1,0]
    v_cvt_pk_bf16_f32 v44, v72, v73
    v_cvt_pk_bf16_f32 v45, v74, v75
    v_cvt_pk_bf16_f32 v46, v76, v77
    v_cvt_pk_bf16_f32 v47, v78, v79
    s_xor_b32 s28, s43, 102400
    buffer_load_dwordx4 a[52:55], v28, s[16:19], s28 offen sc1
    v_exp_f32 v84, v84
    v_exp_f32 v85, v85
    v_exp_f32 v86, v86
    v_exp_f32 v87, v87
    v_exp_f32 v88, v88
    v_exp_f32 v89, v89
    s_xor_b32 s28, s43, 114688
    buffer_load_dwordx4 a[56:59], v28, s[16:19], s28 offen sc1
    v_exp_f32 v90, v90
    v_exp_f32 v91, v91
    v_exp_f32 v92, v92
    v_exp_f32 v93, v93
    v_exp_f32 v94, v94
    v_exp_f32 v95, v95
    s_xor_b32 s28, s43, 118784
    buffer_load_dwordx4 a[60:63], v28, s[16:19], s28 offen sc1
    v_exp_f32 v96, v96
    v_exp_f32 v97, v97
    v_exp_f32 v98, v98
    v_exp_f32 v99, v99
    v_exp_f32 v100, v100
    v_exp_f32 v101, v101
    buffer_load_dwordx4 a[96:99], v1, s[16:19], s40 offen offset:0 sc1
    v_exp_f32 v102, v102
    v_exp_f32 v103, v103
    v_pk_add_f32 v[6:7], v[84:85], v[86:87]
    v_pk_add_f32 v[6:7], v[6:7], v[88:89]
    v_pk_add_f32 v[6:7], v[6:7], v[90:91]
    v_pk_add_f32 v[6:7], v[6:7], v[92:93]
    v_pk_add_f32 v[6:7], v[6:7], v[94:95]
    v_pk_add_f32 v[6:7], v[6:7], v[96:97]
    buffer_load_dwordx4 a[100:103], v1, s[16:19], s40 offen offset:1024 sc1
    v_pk_add_f32 v[6:7], v[6:7], v[98:99]
    v_pk_add_f32 v[6:7], v[6:7], v[100:101]
    v_pk_add_f32 v[6:7], v[6:7], v[102:103]
    v_add_f32 v6, v6, v7
    v_rcp_f32 v6, v6
    v_pk_mul_f32 v[80:81], v[80:81], v[4:5] op_sel_hi:[1,0]
    v_pk_mul_f32 v[82:83], v[82:83], v[4:5] op_sel_hi:[1,0]
    v_pk_mul_f32 v[84:85], v[84:85], v[6:7] op_sel_hi:[1,0]
    v_pk_mul_f32 v[86:87], v[86:87], v[6:7] op_sel_hi:[1,0]
    buffer_load_dwordx4 a[104:107], v1, s[16:19], s40 offen offset:2048 sc1
    v_cvt_pk_bf16_f32 v48, v80, v81
    v_cvt_pk_bf16_f32 v49, v82, v83
    v_cvt_pk_bf16_f32 v50, v84, v85
    v_cvt_pk_bf16_f32 v51, v86, v87
    v_pk_mul_f32 v[88:89], v[88:89], v[6:7] op_sel_hi:[1,0]
    v_pk_mul_f32 v[90:91], v[90:91], v[6:7] op_sel_hi:[1,0]
    v_pk_mul_f32 v[92:93], v[92:93], v[6:7] op_sel_hi:[1,0]
    v_pk_mul_f32 v[94:95], v[94:95], v[6:7] op_sel_hi:[1,0]
    v_cvt_pk_bf16_f32 v52, v88, v89
    buffer_load_dwordx4 a[108:111], v1, s[16:19], s40 offen offset:3072 sc1
    s_add_u32 s40, s40, 4096
    v_cvt_pk_bf16_f32 v53, v90, v91
    v_cvt_pk_bf16_f32 v54, v92, v93
    v_cvt_pk_bf16_f32 v55, v94, v95
    v_pk_mul_f32 v[96:97], v[96:97], v[6:7] op_sel_hi:[1,0]
    v_pk_mul_f32 v[98:99], v[98:99], v[6:7] op_sel_hi:[1,0]
    v_pk_mul_f32 v[100:101], v[100:101], v[6:7] op_sel_hi:[1,0]
    v_pk_mul_f32 v[102:103], v[102:103], v[6:7] op_sel_hi:[1,0]
    v_cvt_pk_bf16_f32 v56, v96, v97
    v_cvt_pk_bf16_f32 v57, v98, v99
    v_cvt_pk_bf16_f32 v58, v100, v101
    v_cvt_pk_bf16_f32 v59, v102, v103
    s_waitcnt vmcnt(19)
    v_mfma_f32_4x4x4_16b_bf16 v[128:131], a[224:225], a[0:1], 0
    v_mfma_f32_4x4x4_16b_bf16 v[132:135], a[224:225], a[2:3], 0
    s_waitcnt vmcnt(18)
    v_mfma_f32_4x4x4_16b_bf16 v[128:131], a[224:225], a[4:5], v[128:131]
    v_mfma_f32_4x4x4_16b_bf16 v[132:135], a[224:225], a[6:7], v[132:135]
    s_waitcnt vmcnt(17)
    v_mfma_f32_4x4x4_16b_bf16 v[128:131], a[224:225], a[8:9], v[128:131]
    v_mfma_f32_4x4x4_16b_bf16 v[132:135], a[224:225], a[10:11], v[132:135]
    s_waitcnt vmcnt(16)
    v_mfma_f32_4x4x4_16b_bf16 v[128:131], a[224:225], a[12:13], v[128:131]
    v_mfma_f32_4x4x4_16b_bf16 v[132:135], a[224:225], a[14:15], v[132:135]
    s_waitcnt vmcnt(15)
    v_mfma_f32_4x4x4_16b_bf16 v[128:131], a[224:225], a[16:17], v[128:131]
    v_mfma_f32_4x4x4_16b_bf16 v[132:135], a[224:225], a[18:19], v[132:135]
    s_waitcnt vmcnt(14)
    v_mfma_f32_4x4x4_16b_bf16 v[128:131], a[224:225], a[20:21], v[128:131]
    v_mfma_f32_4x4x4_16b_bf16 v[132:135], a[224:225], a[22:23], v[132:135]
    s_waitcnt vmcnt(13)
    v_mfma_f32_4x4x4_16b_bf16 v[128:131], a[224:225], a[24:25], v[128:131]
    v_mfma_f32_4x4x4_16b_bf16 v[132:135], a[224:225], a[26:27], v[132:135]
    s_waitcnt vmcnt(12)
    v_mfma_f32_4x4x4_16b_bf16 v[128:131], a[224:225], a[28:29], v[128:131]
    v_mfma_f32_4x4x4_16b_bf16 v[132:135], a[224:225], a[30:31], v[132:135]
    s_waitcnt vmcnt(11)
    v_mfma_f32_4x4x4_16b_bf16 v[128:131], a[224:225], a[32:33], v[128:131]
    v_mfma_f32_4x4x4_16b_bf16 v[132:135], a[224:225], a[34:35], v[132:135]
    buffer_load_dwordx4 a[112:115], v1, s[16:19], s40 offen offset:0 sc1
    s_waitcnt vmcnt(11)
    v_mfma_f32_4x4x4_16b_bf16 v[128:131], a[224:225], a[36:37], v[128:131]
    v_mfma_f32_4x4x4_16b_bf16 v[132:135], a[224:225], a[38:39], v[132:135]
    buffer_load_dwordx4 a[116:119], v1, s[16:19], s40 offen offset:1024 sc1
    s_waitcnt vmcnt(11)
    v_mfma_f32_4x4x4_16b_bf16 v[128:131], a[224:225], a[40:41], v[128:131]
    v_mfma_f32_4x4x4_16b_bf16 v[132:135], a[224:225], a[42:43], v[132:135]
    buffer_load_dwordx4 a[120:123], v1, s[16:19], s40 offen offset:2048 sc1
    s_waitcnt vmcnt(11)
    v_mfma_f32_4x4x4_16b_bf16 v[128:131], a[224:225], a[44:45], v[128:131]
    v_mfma_f32_4x4x4_16b_bf16 v[132:135], a[224:225], a[46:47], v[132:135]
    buffer_load_dwordx4 a[124:127], v1, s[16:19], s40 offen offset:3072 sc1
    s_add_u32 s40, s40, 4096
    s_waitcnt vmcnt(11)
    v_mfma_f32_4x4x4_16b_bf16 v[128:131], a[224:225], a[48:49], v[128:131]
    v_mfma_f32_4x4x4_16b_bf16 v[132:135], a[224:225], a[50:51], v[132:135]
    buffer_load_dwordx4 a[128:131], v1, s[16:19], s40 offen offset:0 sc1
    s_waitcnt vmcnt(11)
    v_mfma_f32_4x4x4_16b_bf16 v[128:131], a[224:225], a[52:53], v[128:131]
    v_mfma_f32_4x4x4_16b_bf16 v[132:135], a[224:225], a[54:55], v[132:135]
    buffer_load_dwordx4 a[132:135], v1, s[16:19], s40 offen offset:1024 sc1
    s_waitcnt vmcnt(11)
    v_mfma_f32_4x4x4_16b_bf16 v[128:131], a[224:225], a[56:57], v[128:131]
    v_mfma_f32_4x4x4_16b_bf16 v[132:135], a[224:225], a[58:59], v[132:135]
    buffer_load_dwordx4 a[136:139], v1, s[16:19], s40 offen offset:2048 sc1
    s_waitcnt vmcnt(11)
    v_mfma_f32_4x4x4_16b_bf16 v[128:131], a[224:225], a[60:61], v[128:131]
    v_mfma_f32_4x4x4_16b_bf16 v[132:135], a[224:225], a[62:63], v[132:135]
    buffer_load_dwordx4 a[140:143], v1, s[16:19], s40 offen offset:3072 sc1
    s_add_u32 s40, s40, 4096
    s_nop 2
    v_cmp_u_f32 s[0:1], v128, v132
    s_nop 0
    s_cmp_eq_u64 s[0:1], 0
    s_cbranch_scc0 L_respec_18
L_specok_19:
    v_cvt_pk_bf16_f32 v60, v128, v129
    v_cvt_pk_bf16_f32 v61, v130, v131
    v_cvt_pk_bf16_f32 v62, v132, v133
    v_cvt_pk_bf16_f32 v63, v134, v135
    ds_write_b128 v10, v[60:63]
    s_waitcnt lgkmcnt(0)
    s_barrier
    ds_read_b128 v[68:71], v12 offset:256
    ds_read_b128 v[64:67], v11 offset:0
    ds_read_b128 v[76:79], v12 offset:640
    ds_read_b128 v[72:75], v11 offset:384
    ds_read_b128 v[84:87], v12 offset:1024
    ds_read_b128 v[80:83], v11 offset:768
    ds_read_b128 v[92:95], v12 offset:1408
    ds_read_b128 v[88:91], v11 offset:1152
    ds_read_b128 v[100:103], v12 offset:1792
    ds_read_b128 v[96:99], v11 offset:1536
    s_waitcnt lgkmcnt(9)
    v_mfma_f32_32x32x16_bf16 v[120:135], v[68:71], v[40:43], 0
    v_and_b32 v28, 15, v0
    v_mov_b32 v9, s6
    s_waitcnt lgkmcnt(8)
    v_mfma_f32_32x32x16_bf16 v[104:119], v[64:67], v[40:43], 0
    v_lshrrev_b32 v6, 2, v9
    v_lshrrev_b32 v7, 3, v28
    s_add_u32 m0, s61, 114688
    s_add_u32 s58, s41, 114688
    buffer_load_dwordx4 v1, s[16:19], s58 offen sc1 lds
    s_waitcnt lgkmcnt(7)
    v_mfma_f32_32x32x16_bf16 v[120:135], v[76:79], v[44:47], v[120:135]
    v_lshl_add_u32 v6, v7, 2, v6
    v_and_b32 v7, 3, v9
    s_waitcnt lgkmcnt(6)
    v_mfma_f32_32x32x16_bf16 v[104:119], v[72:75], v[44:47], v[104:119]
    v_lshl_add_u32 v6, v7, 3, v6
    v_and_b32 v7, 7, v28
    buffer_load_dwordx4 a[144:147], v1, s[16:19], s40 offen offset:0 sc1
    s_waitcnt lgkmcnt(5)
    v_mfma_f32_32x32x16_bf16 v[120:135], v[84:87], v[48:51], v[120:135]
    v_lshl_add_u32 v6, v7, 5, v6
    v_lshlrev_b32 v9, 7, v6
    s_waitcnt lgkmcnt(4)
    v_mfma_f32_32x32x16_bf16 v[104:119], v[80:83], v[48:51], v[104:119]
    v_and_b32 v6, 0x6000, v9
    v_add_u32 v9, v6, v9
    s_add_u32 m0, s61, 118784
    s_add_u32 s58, s41, 118784
    buffer_load_dwordx4 v1, s[16:19], s58 offen sc1 lds
    s_waitcnt lgkmcnt(3)
    v_mfma_f32_32x32x16_bf16 v[120:135], v[92:95], v[52:55], v[120:135]
    v_cmp_eq_u32_e64 vcc, 0, s3
    s_nop 1
    v_cndmask_b32 v9, v3, v9, vcc
    s_waitcnt lgkmcnt(2)
    v_mfma_f32_32x32x16_bf16 v[104:119], v[88:91], v[52:55], v[104:119]
    v_mov_b32 v16, v1
    v_add_u32 v17, 4096, v1
    buffer_load_dwordx4 a[148:151], v1, s[16:19], s40 offen offset:1024 sc1
    s_waitcnt lgkmcnt(1)
    v_mfma_f32_32x32x16_bf16 v[120:135], v[100:103], v[56:59], v[120:135]
    v_add_u32 v18, 16384, v1
    v_add_u32 v19, 20480, v1
    s_waitcnt lgkmcnt(0)
    v_mfma_f32_32x32x16_bf16 v[104:119], v[96:99], v[56:59], v[104:119]
    buffer_load_dwordx4 a[152:155], v1, s[16:19], s40 offen offset:2048 sc1
    s_nop 6
    v_add_f32 v4, 0x358637bd, v124
    v_rcp_f32 v4, v4
    s_nop 0
    v_pk_mul_f32 v[120:121], v[120:121], v[4:5] op_sel_hi:[1,0]
    v_pk_mul_f32 v[122:123], v[122:123], v[4:5] op_sel_hi:[1,0]
    v_cvt_pk_bf16_f32 v72, v120, v121
    v_cvt_pk_bf16_f32 v73, v122, v123
    v_pk_mul_f32 v[104:105], v[104:105], v[4:5] op_sel_hi:[1,0]
    v_pk_mul_f32 v[106:107], v[106:107], v[4:5] op_sel_hi:[1,0]
    v_pk_mul_f32 v[108:109], v[108:109], v[4:5] op_sel_hi:[1,0]
    v_pk_mul_f32 v[110:111], v[110:111], v[4:5] op_sel_hi:[1,0]
    v_cvt_pk_bf16_f32 v64, v104, v105
    v_cvt_pk_bf16_f32 v65, v106, v107
    v_cvt_pk_bf16_f32 v66, v108, v109
    v_cvt_pk_bf16_f32 v67, v110, v111
    buffer_store_dwordx4 v[64:67], v13, s[16:19], 0 offen sc1
    v_permlane32_swap_b32 v72, v74
    v_permlane32_swap_b32 v73, v75
    buffer_store_dwordx4 v[72:75], v25, s[16:19], 0 offen offset:512 sc1
    v_pk_mul_f32 v[112:113], v[112:113], v[4:5] op_sel_hi:[1,0]
    v_pk_mul_f32 v[114:115], v[114:115], v[4:5] op_sel_hi:[1,0]
    v_pk_mul_f32 v[116:117], v[116:117], v[4:5] op_sel_hi:[1,0]
    v_pk_mul_f32 v[118:119], v[118:119], v[4:5] op_sel_hi:[1,0]
    v_cvt_pk_bf16_f32 v68, v112, v113
    v_cvt_pk_bf16_f32 v69, v114, v115
    v_cvt_pk_bf16_f32 v70, v116, v117
    v_cvt_pk_bf16_f32 v71, v118, v119
    buffer_store_dwordx4 v[68:71], v13, s[16:19], 0 offen offset:256 sc1
    s_and_b32 s30, s59, 7
    s_mul_i32 s30, s30, 65536
    s_mul_i32 s29, s57, 17408
    s_add_u32 s30, s30, s29
    s_add_u32 s30, s30, s12
    s_add_u32 s28, s3, 1
    s_and_b32 s28, s28, 3
    s_mul_i32 s29, s28, 10240
    s_add_u32 s29, s29, 122880
    v_add_u32 v20, s29, v1
    s_mul_i32 s28, s28, 65536
    s_add_u32 s24, s28, s30
    s_add_u32 s28, s3, 2
    s_and_b32 s28, s28, 3
    s_mul_i32 s29, s28, 10240
    s_add_u32 s29, s29, 128000
    v_add_u32 v21, s29, v1
    s_mul_i32 s28, s28, 65536
    s_add_u32 s25, s28, s30
    s_add_u32 s28, s3, 3
    s_and_b32 s28, s28, 3
    s_mul_i32 s29, s28, 10240
    s_add_u32 s29, s29, 122880
    v_add_u32 v22, s29, v1
    s_mul_i32 s28, s28, 65536
    s_add_u32 s26, s28, s30
    s_add_u32 s28, s3, 4
    s_and_b32 s28, s28, 3
    s_mul_i32 s29, s28, 10240
    s_add_u32 s29, s29, 122880
    v_add_u32 v23, s29, v1
    s_mul_i32 s28, s28, 65536
    s_add_u32 s27, s28, s30
    s_waitcnt vmcnt(0)
    v_mov_b32 v8, 4
    s_and_b32 s13, s13, 0x2000
    s_barrier
    buffer_store_dword v8, v2, s[16:19], s13 offen sc1
L_c2:
    buffer_load_dwordx4 a[156:159], v1, s[16:19], s40 offen offset:3072 sc1
    s_add_u32 s40, s40, 4096
    v_accvgpr_read_b32 v24, a228
    v_accvgpr_read_b32 v25, a229
    v_accvgpr_read_b32 v26, a230
    v_accvgpr_read_b32 v27, a231
    v_accvgpr_read_b32 v28, a232
    v_accvgpr_read_b32 v29, a233
    v_accvgpr_read_b32 v30, a234
    v_accvgpr_read_b32 v31, a235
    v_accvgpr_read_b32 v32, a236
    v_accvgpr_read_b32 v33, a237
    buffer_load_dwordx4 a[160:163], v1, s[16:19], s40 offen offset:0 sc1
    v_lshlrev_b32 v136, 16, v24
    v_and_b32 v137, 0xffff0000, v24
    v_lshlrev_b32 v138, 16, v25
    v_and_b32 v139, 0xffff0000, v25
    v_lshlrev_b32 v140, 16, v26
    v_and_b32 v141, 0xffff0000, v26
    v_lshlrev_b32 v142, 16, v27
    v_and_b32 v143, 0xffff0000, v27
    v_lshlrev_b32 v144, 16, v28
    v_and_b32 v145, 0xffff0000, v28
    buffer_load_dwordx4 a[164:167], v1, s[16:19], s40 offen offset:1024 sc1
    v_lshlrev_b32 v146, 16, v29
    v_and_b32 v147, 0xffff0000, v29
    v_lshlrev_b32 v148, 16, v30
    v_and_b32 v149, 0xffff0000, v30
    v_lshlrev_b32 v150, 16, v31
    v_and_b32 v151, 0xffff0000, v31
    v_lshlrev_b32 v152, 16, v32
    v_and_b32 v153, 0xffff0000, v32
    v_lshlrev_b32 v154, 16, v33
    v_and_b32 v155, 0xffff0000, v33
    buffer_load_dwordx4 a[168:171], v1, s[16:19], s40 offen offset:2048 sc1
    v_lshrrev_b32 v5, 5, v0
    v_mul_u32_u24 v5, 1280, v5
    v_and_b32 v4, 15, v0
    v_lshl_add_u32 v4, v4, 4, v5
    v_bfe_u32 v6, v0, 4, 1
    s_add_u32 s28, s59, s3
    s_and_b32 s28, s28, 7
    s_lshl_b32 s28, s28, 16
    s_add_u32 s28, s28, s12
    s_add_u32 s28, s28, 524288
    buffer_load_dwordx4 a[172:175], v1, s[16:19], s40 offen offset:3072 sc1
    s_add_u32 s40, s40, 4096
    s_and_b32 s30, s61, 1024
    s_add_u32 s30, s30, s28
    s_lshr_b32 s29, s101, 1
    s_lshl_b32 s29, s29, 14
    s_add_u32 s30, s30, s29
    s_and_b32 s29, s101, 1
    s_mul_i32 s29, s29, 2560
    s_add_u32 s30, s30, s29
    v_add_u32 v4, s30, v4
    v_mul_u32_u24 v7, 768, v6
    buffer_load_dwordx4 a[176:179], v1, s[16:19], s40 offen offset:0 sc1
    v_add_u32 v10, v4, v7
    v_cmp_eq_u32 vcc, 0, v6
    s_nop 1
    v_cndmask_b32 v11, v3, v4, vcc
    s_lshl_b32 s31, s101, 7
    s_add_u32 s31, s31, s28
    s_add_u32 s31, s31, 7168
    v_lshlrev_b32 v4, 3, v0
    v_add_u32 v4, s31, v4
    v_cmp_gt_u32 vcc, 16, v0
    s_nop 1
    v_cndmask_b32 v12, v3, v4, vcc
    buffer_load_dwordx4 a[180:183], v1, s[16:19], s40 offen offset:1024 sc1
    v_mov_b32 v4, s100
    v_accvgpr_write_b32 a48, v4
    v_accvgpr_write_b32 a49, v4
    v_accvgpr_write_b32 a50, v4
    v_accvgpr_write_b32 a51, v4
    buffer_load_dwordx4 a[184:187], v1, s[16:19], s40 offen offset:2048 sc1
    buffer_load_dwordx4 a[188:191], v1, s[16:19], s40 offen offset:3072 sc1
    s_add_u32 s40, s40, 4096
    buffer_load_dwordx4 a[192:195], v1, s[16:19], s40 offen offset:0 sc1
    buffer_load_dwordx4 a[196:199], v1, s[16:19], s40 offen offset:1024 sc1
    buffer_load_dword v8, v9, s[16:19], s15 offen sc1
    buffer_load_dwordx4 a[200:203], v1, s[16:19], s40 offen offset:2048 sc1
    s_nop 0
    buffer_load_dwordx4 a[204:207], v1, s[16:19], s40 offen offset:3072 sc1
    s_add_u32 s40, s40, 4096
    s_nop 0
    buffer_load_dwordx4 a[208:211], v1, s[16:19], s40 offen offset:0 sc1
    s_nop 0
    buffer_load_dwordx4 a[212:215], v1, s[16:19], s40 offen offset:1024 sc1
    s_nop 0
    buffer_load_dwordx4 a[216:219], v1, s[16:19], s40 offen offset:2048 sc1
    s_nop 0
    buffer_load_dwordx4 a[220:223], v1, s[16:19], s40 offen offset:3072 sc1
    s_add_u32 s40, s40, 4096
    s_nop 0
    s_lshl_b32 s28, s3, 11
    v_add_u32 v5, s28, v1
    v_add_u32 v6, 50176, v5
    v_add_u32 v7, 100352, v5
    ds_read_b128 a[32:35], v5 offset:0
    ds_read_b128 a[36:39], v5 offset:1024
    ds_read_b128 a[40:43], v5 offset:7168
    ds_read_b128 a[44:47], v5 offset:8192
    s_waitcnt lgkmcnt(3)
    v_mfma_f32_16x16x32_bf16 a[52:55], a[32:35], a[48:51], 0
    ds_read_b128 a[32:35], v5 offset:14336
    s_waitcnt lgkmcnt(3)
    v_mfma_f32_16x16x32_bf16 a[56:59], a[36:39], a[48:51], 0
    ds_read_b128 a[36:39], v5 offset:15360
    s_waitcnt lgkmcnt(3)
    v_mfma_f32_16x16x32_bf16 a[52:55], a[40:43], a[48:51], a[52:55]
    ds_read_b128 a[40:43], v5 offset:21504
    s_waitcnt lgkmcnt(3)
    v_mfma_f32_16x16x32_bf16 a[56:59], a[44:47], a[48:51], a[56:59]
    ds_read_b128 a[44:47], v5 offset:22528
    s_waitcnt lgkmcnt(3)
    v_mfma_f32_16x16x32_bf16 a[52:55], a[32:35], a[48:51], a[52:55]
    ds_read_b128 a[32:35], v5 offset:28672
    s_waitcnt lgkmcnt(3)
    v_mfma_f32_16x16x32_bf16 a[56:59], a[36:39], a[48:51], a[56:59]
    ds_read_b128 a[36:39], v5 offset:29696
    s_waitcnt lgkmcnt(3)
    v_mfma_f32_16x16x32_bf16 a[52:55], a[40:43], a[48:51], a[52:55]
    ds_read_b128 a[40:43], v5 offset:35840
    s_waitcnt lgkmcnt(3)
    v_mfma_f32_16x16x32_bf16 a[56:59], a[44:47], a[48:51], a[56:59]
    ds_read_b128 a[44:47], v5 offset:36864
    s_waitcnt lgkmcnt(3)
    v_mfma_f32_16x16x32_bf16 a[52:55], a[32:35], a[48:51], a[52:55]
    ds_read_b128 a[32:35], v5 offset:43008
    s_waitcnt lgkmcnt(3)
    v_mfma_f32_16x16x32_bf16 a[56:59], a[36:39], a[48:51], a[56:59]
    ds_read_b128 a[36:39], v5 offset:44032
    s_waitcnt lgkmcnt(3)
    v_mfma_f32_16x16x32_bf16 a[52:55], a[40:43], a[48:51], a[52:55]
    ds_read_b128 a[40:43], v6 offset:0
    s_waitcnt lgkmcnt(3)
    v_mfma_f32_16x16x32_bf16 a[56:59], a[44:47], a[48:51], a[56:59]
    ds_read_b128 a[44:47], v6 offset:1024
    s_waitcnt lgkmcnt(3)
    v_mfma_f32_16x16x32_bf16 a[52:55], a[32:35], a[48:51], a[52:55]
    ds_read_b128 a[32:35], v6 offset:7168
    s_waitcnt lgkmcnt(3)
    v_mfma_f32_16x16x32_bf16 a[56:59], a[36:39], a[48:51], a[56:59]
    ds_read_b128 a[36:39], v6 offset:8192
    s_waitcnt lgkmcnt(3)
    v_mfma_f32_16x16x32_bf16 a[52:55], a[40:43], a[48:51], a[52:55]
    ds_read_b128 a[40:43], v6 offset:14336
    s_waitcnt lgkmcnt(3)
    v_mfma_f32_16x16x32_bf16 a[56:59], a[44:47], a[48:51], a[56:59]
    ds_read_b128 a[44:47], v6 offset:15360
    s_waitcnt lgkmcnt(3)
    v_mfma_f32_16x16x32_bf16 a[52:55], a[32:35], a[48:51], a[52:55]
    s_waitcnt lgkmcnt(2)
    v_mfma_f32_16x16x32_bf16 a[56:59], a[36:39], a[48:51], a[56:59]
    s_waitcnt lgkmcnt(1)
    v_mfma_f32_16x16x32_bf16 a[52:55], a[40:43], a[48:51], a[52:55]
    s_waitcnt lgkmcnt(0)
    v_mfma_f32_16x16x32_bf16 a[56:59], a[44:47], a[48:51], a[56:59]
    s_cmp_lg_u32 s3, 0
    s_cbranch_scc1 L_polled_21
    s_waitcnt vmcnt(6)
    v_cmp_gt_u32 s[0:1], 4, v8
    s_mov_b32 s94, 0
    s_cmp_eq_u64 s[0:1], 0
    s_cbranch_scc1 L_polled_21
L_poll_20:
    s_add_u32 s94, s94, 1
    buffer_load_dword v8, v9, s[16:19], s15 offen sc1
    s_cmp_gt_u32 s94, 0x40000
    s_cbranch_scc1 L_polled_21
    s_waitcnt vmcnt(0)
    v_cmp_gt_u32 s[0:1], 4, v8
    s_nop 0
    s_cmp_eq_u64 s[0:1], 0
    s_cbranch_scc0 L_poll_20
L_polled_21:
    s_barrier
    buffer_load_dwordx4 a[0:3], v16, s[16:19], s24 offen offset:0 sc1
    buffer_load_dwordx4 a[4:7], v16, s[16:19], s24 offen offset:1024 sc1
    s_nop 0
    buffer_load_dwordx4 a[8:11], v16, s[16:19], s24 offen offset:2048 sc1
    buffer_load_dwordx4 a[12:15], v16, s[16:19], s24 offen offset:3072 sc1
    s_nop 0
    buffer_load_dwordx4 a[16:19], v17, s[16:19], s24 offen offset:0 sc1
    buffer_load_dwordx4 a[20:23], v16, s[16:19], s25 offen offset:0 sc1
    s_nop 0
    buffer_load_dwordx4 a[24:27], v16, s[16:19], s25 offen offset:1024 sc1
    buffer_load_dwordx4 a[28:31], v16, s[16:19], s25 offen offset:2048 sc1
    s_nop 0
    s_waitcnt vmcnt(7)
    v_mfma_f32_16x16x32_bf16 v[36:39], v[156:159], a[0:3], 0
    buffer_load_dwordx4 a[32:35], v16, s[16:19], s25 offen offset:3072 sc1
    v_mfma_f32_16x16x32_bf16 v[40:43], v[160:163], a[0:3], 0
    v_mfma_f32_16x16x32_bf16 v[44:47], v[164:167], a[0:3], 0
    v_mfma_f32_16x16x32_bf16 v[48:51], v[168:171], a[0:3], 0
    v_mfma_f32_16x16x32_bf16 v[52:55], v[172:175], a[0:3], 0
    s_waitcnt vmcnt(7)
    v_mfma_f32_16x16x32_bf16 v[36:39], v[176:179], a[4:7], v[36:39]
    buffer_load_dwordx4 a[36:39], v17, s[16:19], s25 offen offset:0 sc1
    v_mfma_f32_16x16x32_bf16 v[40:43], v[180:183], a[4:7], v[40:43]
    v_mfma_f32_16x16x32_bf16 v[44:47], v[184:187], a[4:7], v[44:47]
    v_mfma_f32_16x16x32_bf16 v[48:51], v[188:191], a[4:7], v[48:51]
    v_mfma_f32_16x16x32_bf16 v[52:55], v[192:195], a[4:7], v[52:55]
    s_waitcnt vmcnt(7)
    v_mfma_f32_16x16x32_bf16 v[36:39], v[196:199], a[8:11], v[36:39]
    buffer_load_dwordx4 a[40:43], v16, s[16:19], s26 offen offset:0 sc1
    v_mfma_f32_16x16x32_bf16 v[40:43], v[200:203], a[8:11], v[40:43]
    v_mfma_f32_16x16x32_bf16 v[44:47], v[204:207], a[8:11], v[44:47]
    v_mfma_f32_16x16x32_bf16 v[48:51], v[208:211], a[8:11], v[48:51]
    v_mfma_f32_16x16x32_bf16 v[52:55], v[212:215], a[8:11], v[52:55]
    s_waitcnt vmcnt(7)
    v_mfma_f32_16x16x32_bf16 v[36:39], v[216:219], a[12:15], v[36:39]
    buffer_load_dwordx4 a[44:47], v16, s[16:19], s26 offen offset:1024 sc1
    v_mfma_f32_16x16x32_bf16 v[40:43], v[220:223], a[12:15], v[40:43]
    v_mfma_f32_16x16x32_bf16 v[44:47], v[224:227], a[12:15], v[44:47]
    v_mfma_f32_16x16x32_bf16 v[48:51], v[228:231], a[12:15], v[48:51]
    v_mfma_f32_16x16x32_bf16 v[52:55], v[232:235], a[12:15], v[52:55]
    s_waitcnt vmcnt(7)
    v_mfma_f32_16x16x32_bf16 v[36:39], v[236:239], a[16:19], v[36:39]
    buffer_load_dwordx4 a[0:3], v16, s[16:19], s26 offen offset:2048 sc1
    v_mfma_f32_16x16x32_bf16 v[40:43], v[240:243], a[16:19], v[40:43]
    v_mfma_f32_16x16x32_bf16 v[44:47], v[244:247], a[16:19], v[44:47]
    v_mfma_f32_16x16x32_bf16 v[48:51], v[248:251], a[16:19], v[48:51]
    v_mfma_f32_16x16x32_bf16 v[52:55], v[252:255], a[16:19], v[52:55]
    s_waitcnt vmcnt(7)
    v_mfma_f32_16x16x32_bf16 v[56:59], v[156:159], a[20:23], 0
    buffer_load_dwordx4 a[4:7], v16, s[16:19], s26 offen offset:3072 sc1
    v_mfma_f32_16x16x32_bf16 v[60:63], v[160:163], a[20:23], 0
    v_mfma_f32_16x16x32_bf16 v[64:67], v[164:167], a[20:23], 0
    v_mfma_f32_16x16x32_bf16 v[68:71], v[168:171], a[20:23], 0
    v_mfma_f32_16x16x32_bf16 v[72:75], v[172:175], a[20:23], 0
    ds_write_b128 v20, v[36:39] offset:0
    s_waitcnt vmcnt(7)
    v_mfma_f32_16x16x32_bf16 v[56:59], v[176:179], a[24:27], v[56:59]
    buffer_load_dwordx4 a[8:11], v17, s[16:19], s26 offen offset:0 sc1
    v_mfma_f32_16x16x32_bf16 v[60:63], v[180:183], a[24:27], v[60:63]
    v_mfma_f32_16x16x32_bf16 v[64:67], v[184:187], a[24:27], v[64:67]
    v_mfma_f32_16x16x32_bf16 v[68:71], v[188:191], a[24:27], v[68:71]
    ds_write_b128 v20, v[40:43] offset:1024
    v_mfma_f32_16x16x32_bf16 v[72:75], v[192:195], a[24:27], v[72:75]
    s_waitcnt vmcnt(7)
    v_mfma_f32_16x16x32_bf16 v[56:59], v[196:199], a[28:31], v[56:59]
    buffer_load_dwordx4 a[12:15], v16, s[16:19], s27 offen offset:0 sc1
    v_mfma_f32_16x16x32_bf16 v[60:63], v[200:203], a[28:31], v[60:63]
    v_mfma_f32_16x16x32_bf16 v[64:67], v[204:207], a[28:31], v[64:67]
    ds_write_b128 v20, v[44:47] offset:2048
    v_mfma_f32_16x16x32_bf16 v[68:71], v[208:211], a[28:31], v[68:71]
    v_mfma_f32_16x16x32_bf16 v[72:75], v[212:215], a[28:31], v[72:75]
    s_waitcnt vmcnt(7)
    v_mfma_f32_16x16x32_bf16 v[56:59], v[216:219], a[32:35], v[56:59]
    buffer_load_dwordx4 a[16:19], v16, s[16:19], s27 offen offset:1024 sc1
    v_mfma_f32_16x16x32_bf16 v[60:63], v[220:223], a[32:35], v[60:63]
    ds_write_b128 v20, v[48:51] offset:3072
    v_mfma_f32_16x16x32_bf16 v[64:67], v[224:227], a[32:35], v[64:67]
    v_mfma_f32_16x16x32_bf16 v[68:71], v[228:231], a[32:35], v[68:71]
    v_mfma_f32_16x16x32_bf16 v[72:75], v[232:235], a[32:35], v[72:75]
    s_waitcnt vmcnt(7)
    v_mfma_f32_16x16x32_bf16 v[56:59], v[236:239], a[36:39], v[56:59]
    ds_write_b128 v20, v[52:55] offset:4096
    buffer_load_dwordx4 a[20:23], v16, s[16:19], s27 offen offset:2048 sc1
    v_mfma_f32_16x16x32_bf16 v[60:63], v[240:243], a[36:39], v[60:63]
    v_mfma_f32_16x16x32_bf16 v[64:67], v[244:247], a[36:39], v[64:67]
    v_mfma_f32_16x16x32_bf16 v[68:71], v[248:251], a[36:39], v[68:71]
    v_mfma_f32_16x16x32_bf16 v[72:75], v[252:255], a[36:39], v[72:75]
    s_waitcnt vmcnt(7)
    v_mfma_f32_16x16x32_bf16 v[36:39], v[156:159], a[40:43], 0
    buffer_load_dwordx4 a[24:27], v16, s[16:19], s27 offen offset:3072 sc1
    v_mfma_f32_16x16x32_bf16 v[40:43], v[160:163], a[40:43], 0
    s_waitcnt lgkmcnt(0)
    s_barrier
    ds_read_b128 v[76:79], v23 offset:0
    v_mfma_f32_16x16x32_bf16 v[44:47], v[164:167], a[40:43], 0
    ds_read_b128 v[80:83], v23 offset:1024
    v_mfma_f32_16x16x32_bf16 v[48:51], v[168:171], a[40:43], 0
    ds_read_b128 v[84:87], v23 offset:2048
    v_mfma_f32_16x16x32_bf16 v[52:55], v[172:175], a[40:43], 0
    ds_write_b128 v21, v[56:59] offset:0
    s_waitcnt vmcnt(7)
    v_mfma_f32_16x16x32_bf16 v[36:39], v[176:179], a[44:47], v[36:39]
    ds_read_b128 v[88:91], v23 offset:3072
    buffer_load_dwordx4 a[28:31], v17, s[16:19], s27 offen offset:0 sc1
    v_mfma_f32_16x16x32_bf16 v[40:43], v[180:183], a[44:47], v[40:43]
    ds_read_b128 v[92:95], v23 offset:4096
    v_mfma_f32_16x16x32_bf16 v[44:47], v[184:187], a[44:47], v[44:47]
    v_mfma_f32_16x16x32_bf16 v[48:51], v[188:191], a[44:47], v[48:51]
    ds_write_b128 v21, v[60:63] offset:1024
    v_mfma_f32_16x16x32_bf16 v[52:55], v[192:195], a[44:47], v[52:55]
    s_waitcnt vmcnt(7)
    v_mfma_f32_16x16x32_bf16 v[36:39], v[196:199], a[0:3], v[36:39]
    buffer_load_dwordx4 a[224:227], v1, s[16:19], s40 offen offset:0 sc1
    v_mfma_f32_16x16x32_bf16 v[40:43], v[200:203], a[0:3], v[40:43]
    v_mfma_f32_16x16x32_bf16 v[44:47], v[204:207], a[0:3], v[44:47]
    ds_write_b128 v21, v[64:67] offset:2048
    v_mfma_f32_16x16x32_bf16 v[48:51], v[208:211], a[0:3], v[48:51]
    v_mfma_f32_16x16x32_bf16 v[52:55], v[212:215], a[0:3], v[52:55]
    s_waitcnt vmcnt(7)
    v_mfma_f32_16x16x32_bf16 v[36:39], v[216:219], a[4:7], v[36:39]
    buffer_load_dwordx4 a[228:231], v1, s[16:19], s40 offen offset:1024 sc1
    v_mfma_f32_16x16x32_bf16 v[40:43], v[220:223], a[4:7], v[40:43]
    ds_write_b128 v21, v[68:71] offset:3072
    v_mfma_f32_16x16x32_bf16 v[44:47], v[224:227], a[4:7], v[44:47]
    v_mfma_f32_16x16x32_bf16 v[48:51], v[228:231], a[4:7], v[48:51]
    v_mfma_f32_16x16x32_bf16 v[52:55], v[232:235], a[4:7], v[52:55]
    s_waitcnt vmcnt(7)
    v_mfma_f32_16x16x32_bf16 v[36:39], v[236:239], a[8:11], v[36:39]
    ds_write_b128 v21, v[72:75] offset:4096
    buffer_load_dwordx4 a[232:235], v1, s[16:19], s40 offen offset:2048 sc1
    v_mfma_f32_16x16x32_bf16 v[40:43], v[240:243], a[8:11], v[40:43]
    v_mfma_f32_16x16x32_bf16 v[44:47], v[244:247], a[8:11], v[44:47]
    v_mfma_f32_16x16x32_bf16 v[48:51], v[248:251], a[8:11], v[48:51]
    v_mfma_f32_16x16x32_bf16 v[52:55], v[252:255], a[8:11], v[52:55]
    s_waitcnt vmcnt(7)
    v_mfma_f32_16x16x32_bf16 v[56:59], v[156:159], a[12:15], v[136:139]
    buffer_load_dwordx4 a[236:239], v1, s[16:19], s40 offen offset:3072 sc1
    s_add_u32 s40, s40, 4096
    v_mfma_f32_16x16x32_bf16 v[60:63], v[160:163], a[12:15], v[140:143]
    s_waitcnt lgkmcnt(0)
    s_barrier
    ds_read_b128 v[96:99], v23 offset:5120
    v_mfma_f32_16x16x32_bf16 v[64:67], v[164:167], a[12:15], v[144:147]
    ds_read_b128 v[100:103], v23 offset:6144
    v_mfma_f32_16x16x32_bf16 v[68:71], v[168:171], a[12:15], v[148:151]
    ds_read_b128 v[104:107], v23 offset:7168
    v_mfma_f32_16x16x32_bf16 v[72:75], v[172:175], a[12:15], v[152:155]
    ds_write_b128 v22, v[36:39] offset:0
    s_waitcnt vmcnt(7)
    v_mfma_f32_16x16x32_bf16 v[56:59], v[176:179], a[16:19], v[56:59]
    ds_read_b128 v[108:111], v23 offset:8192
    buffer_load_dwordx4 a[240:243], v1, s[16:19], s40 offen offset:0 sc1
    v_mfma_f32_16x16x32_bf16 v[60:63], v[180:183], a[16:19], v[60:63]
    ds_read_b128 v[112:115], v23 offset:9216
    v_mfma_f32_16x16x32_bf16 v[64:67], v[184:187], a[16:19], v[64:67]
    ds_write_b128 v22, v[40:43] offset:1024
    v_mfma_f32_16x16x32_bf16 v[68:71], v[188:191], a[16:19], v[68:71]
    v_mfma_f32_16x16x32_bf16 v[72:75], v[192:195], a[16:19], v[72:75]
    s_waitcnt vmcnt(7)
    v_mfma_f32_16x16x32_bf16 v[56:59], v[196:199], a[20:23], v[56:59]
    ds_write_b128 v22, v[44:47] offset:2048
    buffer_load_dwordx4 a[244:247], v1, s[16:19], s40 offen offset:1024 sc1
    v_mfma_f32_16x16x32_bf16 v[60:63], v[200:203], a[20:23], v[60:63]
    s_waitcnt lgkmcnt(7)
    v_add_f32 v76, v76, v96
    v_add_f32 v77, v77, v97
    v_mfma_f32_16x16x32_bf16 v[64:67], v[204:207], a[20:23], v[64:67]
    v_add_f32 v78, v78, v98
    v_add_f32 v79, v79, v99
    v_mfma_f32_16x16x32_bf16 v[68:71], v[208:211], a[20:23], v[68:71]
    ds_write_b128 v22, v[48:51] offset:3072
    s_waitcnt lgkmcnt(7)
    v_add_f32 v80, v80, v100
    v_add_f32 v81, v81, v101
    v_mfma_f32_16x16x32_bf16 v[72:75], v[212:215], a[20:23], v[72:75]
    v_add_f32 v82, v82, v102
    v_add_f32 v83, v83, v103
    s_waitcnt vmcnt(7)
    v_mfma_f32_16x16x32_bf16 v[56:59], v[216:219], a[24:27], v[56:59]
    buffer_load_dwordx4 a[248:251], v1, s[16:19], s40 offen offset:2048 sc1
    s_waitcnt lgkmcnt(6)
    v_add_f32 v84, v84, v104
    v_add_f32 v85, v85, v105
    v_mfma_f32_16x16x32_bf16 v[60:63], v[220:223], a[24:27], v[60:63]
    ds_write_b128 v22, v[52:55] offset:4096
    v_add_f32 v86, v86, v106
    v_add_f32 v87, v87, v107
    v_mfma_f32_16x16x32_bf16 v[64:67], v[224:227], a[24:27], v[64:67]
    s_waitcnt lgkmcnt(5)
    v_add_f32 v88, v88, v108
    v_add_f32 v89, v89, v109
    v_mfma_f32_16x16x32_bf16 v[68:71], v[228:231], a[24:27], v[68:71]
    v_add_f32 v90, v90, v110
    v_add_f32 v91, v91, v111
    v_mfma_f32_16x16x32_bf16 v[72:75], v[232:235], a[24:27], v[72:75]
    s_waitcnt lgkmcnt(4)
    v_add_f32 v92, v92, v112
    v_add_f32 v93, v93, v113
    s_waitcnt vmcnt(7)
    v_mfma_f32_16x16x32_bf16 v[56:59], v[236:239], a[28:31], v[56:59]
    s_waitcnt lgkmcnt(0)
    s_barrier
    ds_read_b128 v[116:119], v23 offset:0
    ds_read_b128 v[120:123], v23 offset:1024
    ds_read_b128 v[124:127], v23 offset:2048
    ds_read_b128 v[128:131], v23 offset:3072
    ds_read_b128 v[132:135], v23 offset:4096
    buffer_load_dwordx4 a[252:255], v1, s[16:19], s40 offen offset:3072 sc1
    s_add_u32 s40, s40, 4096
    v_add_f32 v94, v94, v114
    v_add_f32 v95, v95, v115
    v_mfma_f32_16x16x32_bf16 v[60:63], v[240:243], a[28:31], v[60:63]
    v_mfma_f32_16x16x32_bf16 v[64:67], v[244:247], a[28:31], v[64:67]
    v_mfma_f32_16x16x32_bf16 v[68:71], v[248:251], a[28:31], v[68:71]
    v_mfma_f32_16x16x32_bf16 v[72:75], v[252:255], a[28:31], v[72:75]
    s_waitcnt lgkmcnt(4)
    v_pk_add_f32 v[76:77], v[76:77], v[116:117]
    v_pk_add_f32 v[78:79], v[78:79], v[118:119]
    s_waitcnt lgkmcnt(3)
    v_pk_add_f32 v[80:81], v[80:81], v[120:121]
    v_pk_add_f32 v[82:83], v[82:83], v[122:123]
    s_waitcnt lgkmcnt(2)
    v_pk_add_f32 v[84:85], v[84:85], v[124:125]
    v_pk_add_f32 v[86:87], v[86:87], v[126:127]
    s_waitcnt lgkmcnt(1)
    v_pk_add_f32 v[88:89], v[88:89], v[128:129]
    v_pk_add_f32 v[90:91], v[90:91], v[130:131]
    s_waitcnt lgkmcnt(0)
    v_pk_add_f32 v[92:93], v[92:93], v[132:133]
    v_pk_add_f32 v[94:95], v[94:95], v[134:135]
    v_pk_add_f32 v[76:77], v[76:77], v[56:57]
    v_pk_add_f32 v[78:79], v[78:79], v[58:59]
    v_pk_add_f32 v[80:81], v[80:81], v[60:61]
    v_pk_add_f32 v[82:83], v[82:83], v[62:63]
    v_pk_add_f32 v[84:85], v[84:85], v[64:65]
    v_pk_add_f32 v[86:87], v[86:87], v[66:67]
    v_pk_add_f32 v[88:89], v[88:89], v[68:69]
    v_pk_add_f32 v[90:91], v[90:91], v[70:71]
    v_pk_add_f32 v[92:93], v[92:93], v[72:73]
    v_pk_add_f32 v[94:95], v[94:95], v[74:75]
    v_cvt_pk_bf16_f32 v24, v76, v77
    v_cvt_pk_bf16_f32 v25, v78, v79
    v_cvt_pk_bf16_f32 v26, v80, v81
    v_cvt_pk_bf16_f32 v27, v82, v83
    buffer_store_dwordx4 v[24:27], v10, s[16:19], 0 offen sc1
    v_mov_b32 v40, 0
    v_mov_b32 v41, 0
    v_cvt_pk_bf16_f32 v28, v84, v85
    v_cvt_pk_bf16_f32 v29, v86, v87
    v_cvt_pk_bf16_f32 v30, v88, v89
    v_cvt_pk_bf16_f32 v31, v90, v91
    v_cvt_pk_bf16_f32 v32, v92, v93
    v_cvt_pk_bf16_f32 v33, v94, v95
    v_mov_b32 v36, v32
    v_mov_b32 v37, v33
    v_dot2c_f32_bf16 v40, s100, v24
    v_dot2c_f32_bf16 v41, v24, v24
    v_dot2c_f32_bf16 v40, s100, v25
    v_dot2c_f32_bf16 v41, v25, v25
    buffer_store_dwordx4 v[28:31], v10, s[16:19], 0 offen offset:256 sc1
    v_permlane16_swap_b32 v36, v38
    v_permlane16_swap_b32 v37, v39
    v_dot2c_f32_bf16 v40, s100, v26
    v_dot2c_f32_bf16 v41, v26, v26
    v_dot2c_f32_bf16 v40, s100, v27
    v_dot2c_f32_bf16 v41, v27, v27
    v_dot2c_f32_bf16 v40, s100, v28
    v_dot2c_f32_bf16 v41, v28, v28
    v_dot2c_f32_bf16 v40, s100, v29
    v_dot2c_f32_bf16 v41, v29, v29
    v_dot2c_f32_bf16 v40, s100, v30
    v_dot2c_f32_bf16 v41, v30, v30
    buffer_store_dwordx4 v[36:39], v11, s[16:19], 0 offen offset:512 sc1
    v_dot2c_f32_bf16 v40, s100, v31
    v_dot2c_f32_bf16 v41, v31, v31
    v_dot2c_f32_bf16 v40, s100, v32
    v_dot2c_f32_bf16 v41, v32, v32
    v_dot2c_f32_bf16 v40, s100, v33
    v_dot2c_f32_bf16 v41, v33, v33
    s_nop 1
    v_mov_b32 v42, v40
    v_mov_b32 v43, v41
    s_nop 0
    v_permlane16_swap_b32 v40, v42
    v_permlane16_swap_b32 v41, v43
    v_pk_add_f32 v[40:41], v[40:41], v[42:43]
    v_mov_b32 v42, v40
    v_mov_b32 v43, v41
    s_nop 0
    v_permlane32_swap_b32 v40, v42
    v_permlane32_swap_b32 v41, v43
    v_pk_add_f32 v[40:41], v[40:41], v[42:43]
    buffer_store_dwordx2 v[40:41], v12, s[16:19], 0 offen sc1
    s_barrier
    s_mov_b32 s20, s44
    s_mov_b32 s21, s45
    s_mov_b32 s22, 3456
    s_mov_b32 s23, 0x20000
    s_mul_i32 s43, s7, 216
    s_add_u32 s22, s43, 216
    v_lshlrev_b32 v35, 2, v0
    s_mov_b32 m0, 147456
    s_nop 0
    buffer_load_dword v35, s[20:23], s43 offen lds
    s_mov_b32 s20, s48
    s_mov_b32 s21, s49
    s_mov_b32 s22, 1280
    s_mov_b32 s23, 0x20000
    s_mul_i32 s43, s101, 160
    s_add_u32 s22, s43, 160
    v_lshlrev_b32 v35, 2, v0
    s_mov_b32 m0, 147712
    s_nop 0
    buffer_load_dword v35, s[20:23], s43 offen lds
    s_add_u32 m0, s61, 122880
    s_add_u32 s58, s41, 122880
    buffer_load_dwordx4 v1, s[16:19], s58 offen sc1 lds
    v_mov_b32 v10, v1
    v_add_u32 v11, 50176, v1
    v_add_u32 v12, 100352, v1
    s_and_b32 s28, s6, 1
    s_lshl_b32 s28, s28, 3
    s_lshr_b32 s29, s6, 1
    s_add_u32 s28, s28, s29
    s_lshl_b32 s28, s28, 7
    v_and_b32 v9, 15, v0
    v_lshlrev_b32 v9, 11, v9
    s_add_u32 m0, s61, 126976
    s_add_u32 s58, s41, 126976
    buffer_load_dwordx4 v1, s[16:19], s58 offen sc1 lds
    v_add_u32 v9, s28, v9
    v_and_b32 v6, 0x6000, v9
    v_add_u32 v9, v6, v9
    v_cmp_eq_u32_e64 vcc, 0, s3
    s_nop 1
    v_cndmask_b32 v9, v3, v9, vcc
    s_add_u32 m0, s61, 131072
    s_add_u32 s58, s41, 131072
    buffer_load_dwordx4 v1, s[16:19], s58 offen sc1 lds
    s_add_u32 m0, s61, 135168
    s_add_u32 s58, s41, 135168
    buffer_load_dwordx4 v1, s[16:19], s58 offen sc1 lds
    s_add_u32 m0, s61, 139264
    s_add_u32 s58, s41, 139264
    buffer_load_dwordx4 v1, s[16:19], s58 offen sc1 lds
    s_waitcnt vmcnt(7)
    v_mov_b32 v8, 5
    s_barrier
    buffer_store_dword v8, v2, s[16:19], s95 offen
L_c3:
    s_lshl_b32 s28, s3, 11
    v_add_u32 v5, s28, v1
    v_add_u32 v6, 50176, v5
    v_add_u32 v7, 100352, v5
    ds_read_b128 a[32:35], v6 offset:21504
    ds_read_b128 a[36:39], v6 offset:22528
    ds_read_b128 a[40:43], v6 offset:28672
    ds_read_b128 a[44:47], v6 offset:29696
    s_waitcnt lgkmcnt(3)
    v_mfma_f32_16x16x32_bf16 a[52:55], a[32:35], a[48:51], a[52:55]
    ds_read_b128 a[32:35], v6 offset:35840
    s_waitcnt lgkmcnt(3)
    v_mfma_f32_16x16x32_bf16 a[56:59], a[36:39], a[48:51], a[56:59]
    ds_read_b128 a[36:39], v6 offset:36864
    s_waitcnt lgkmcnt(3)
    v_mfma_f32_16x16x32_bf16 a[52:55], a[40:43], a[48:51], a[52:55]
    ds_read_b128 a[40:43], v6 offset:43008
    s_waitcnt lgkmcnt(3)
    v_mfma_f32_16x16x32_bf16 a[56:59], a[44:47], a[48:51], a[56:59]
    ds_read_b128 a[44:47], v6 offset:44032
    s_waitcnt lgkmcnt(3)
    v_mfma_f32_16x16x32_bf16 a[52:55], a[32:35], a[48:51], a[52:55]
    ds_read_b128 a[32:35], v7 offset:0
    s_waitcnt lgkmcnt(3)
    v_mfma_f32_16x16x32_bf16 a[56:59], a[36:39], a[48:51], a[56:59]
    ds_read_b128 a[36:39], v7 offset:1024
    s_waitcnt lgkmcnt(3)
    v_mfma_f32_16x16x32_bf16 a[52:55], a[40:43], a[48:51], a[52:55]
    ds_read_b128 a[40:43], v7 offset:7168
    s_waitcnt lgkmcnt(3)
    v_mfma_f32_16x16x32_bf16 a[56:59], a[44:47], a[48:51], a[56:59]
    ds_read_b128 a[44:47], v7 offset:8192
    s_waitcnt lgkmcnt(3)
    v_mfma_f32_16x16x32_bf16 a[52:55], a[32:35], a[48:51], a[52:55]
    ds_read_b128 a[32:35], v7 offset:14336
    s_waitcnt lgkmcnt(3)
    v_mfma_f32_16x16x32_bf16 a[56:59], a[36:39], a[48:51], a[56:59]
    ds_read_b128 a[36:39], v7 offset:15360
    s_waitcnt lgkmcnt(3)
    v_mfma_f32_16x16x32_bf16 a[52:55], a[40:43], a[48:51], a[52:55]
    s_waitcnt lgkmcnt(2)
    v_mfma_f32_16x16x32_bf16 a[56:59], a[44:47], a[48:51], a[56:59]
    s_waitcnt lgkmcnt(1)
    v_mfma_f32_16x16x32_bf16 a[52:55], a[32:35], a[48:51], a[52:55]
    s_waitcnt lgkmcnt(0)
    v_mfma_f32_16x16x32_bf16 a[56:59], a[36:39], a[48:51], a[56:59]
    v_mov_b32 v35, 5
    s_lshl_b32 s24, s3, 17
    s_add_u32 s24, s24, s12
    s_add_u32 s25, s24, 531456
    s_add_u32 s26, s25, 65536
    s_add_u32 s32, s24, 524288
    s_add_u32 s33, s24, 528384
    s_add_u32 s34, s24, 540672
    s_add_u32 s35, s24, 544768
    s_add_u32 s36, s24, 557056
    s_add_u32 s37, s24, 561152
    s_add_u32 s38, s24, 573440
    s_add_u32 s39, s24, 577536
    s_lshl_b32 s27, s3, 18
    s_add_u32 s27, s27, s92
    s_lshr_b32 s29, s7, 2
    s_lshl_b32 s29, s29, 15
    s_add_u32 s27, s27, s29
    s_and_b32 s29, s7, 3
    s_lshl_b32 s29, s29, 9
    s_add_u32 s27, s27, s29
    s_add_u32 s47, s27, 20480
    s_add_u32 s27, s27, s29
    s_add_u32 s46, s27, 16384
    s_lshl_b32 s29, s29, 1
    s_add_u32 s27, s27, s29
    v_add_u32 v13, 66560, v1
    v_add_u32 v20, 131072, v1
    v_lshlrev_b32 v22, 3, v0
    v_and_b32 v4, 48, v0
    s_lshl_b32 s28, s3, 7
    s_add_u32 s28, s28, 157696
    v_add_u32 v23, s28, v4
    v_add_u32 v21, 157696, v4
    v_add_u32 v126, 147456, v4
    v_lshrrev_b32 v4, 1, v4
    v_add_u32 v127, 147456, v4
    buffer_load_dword v8, v9, s[16:19], s95 offen sc1
    buffer_load_dwordx4 v[156:159], v1, s[16:19], s40 offen offset:0 sc1
    s_nop 0
    buffer_load_dwordx4 v[160:163], v1, s[16:19], s40 offen offset:1024 sc1
    s_nop 0
    buffer_load_dwordx4 v[164:167], v1, s[16:19], s40 offen offset:2048 sc1
    s_nop 0
    buffer_load_dwordx4 v[168:171], v1, s[16:19], s40 offen offset:3072 sc1
    s_add_u32 s40, s40, 4096
    s_nop 0
    s_waitcnt vmcnt(11)
    ds_read_b128 v[128:131], v126 offset:0
    ds_read_b128 v[132:135], v126 offset:64
    ds_read_b128 v[136:139], v126 offset:128
    ds_read_b64 v[140:141], v127 offset:192
    v_bfe_u32 v4, v0, 4, 1
    v_lshlrev_b32 v4, 17, v4
    v_lshrrev_b32 v5, 5, v0
    v_lshl_add_u32 v4, v5, 8, v4
    v_and_b32 v5, 15, v0
    v_lshl_add_u32 v4, v5, 4, v4
    s_waitcnt lgkmcnt(3)
    v_lshlrev_b32 v100, 16, v128
    v_and_b32 v101, 0xffff0000, v128
    v_lshlrev_b32 v102, 16, v129
    v_and_b32 v103, 0xffff0000, v129
    v_lshlrev_b32 v104, 16, v130
    v_and_b32 v105, 0xffff0000, v130
    v_lshlrev_b32 v106, 16, v131
    v_and_b32 v107, 0xffff0000, v131
    s_waitcnt lgkmcnt(2)
    v_lshlrev_b32 v108, 16, v132
    v_and_b32 v109, 0xffff0000, v132
    v_lshlrev_b32 v110, 16, v133
    v_and_b32 v111, 0xffff0000, v133
    v_lshlrev_b32 v112, 16, v134
    v_and_b32 v113, 0xffff0000, v134
    v_lshlrev_b32 v114, 16, v135
    v_and_b32 v115, 0xffff0000, v135
    s_waitcnt lgkmcnt(1)
    v_lshlrev_b32 v116, 16, v136
    v_and_b32 v117, 0xffff0000, v136
    v_lshlrev_b32 v118, 16, v137
    v_and_b32 v119, 0xffff0000, v137
    v_lshlrev_b32 v120, 16, v138
    v_and_b32 v121, 0xffff0000, v138
    v_lshlrev_b32 v122, 16, v139
    v_and_b32 v123, 0xffff0000, v139
    s_waitcnt lgkmcnt(0)
    v_lshlrev_b32 v124, 16, v140
    v_and_b32 v125, 0xffff0000, v140
    v_lshlrev_b32 v126, 16, v141
    v_and_b32 v127, 0xffff0000, v141
    s_waitcnt vmcnt(6)
    s_cmp_lg_u32 s3, 0
    s_cbranch_scc1 L_polled_23
    s_waitcnt vmcnt(4)
    v_cmp_gt_u32 s[0:1], 5, v8
    s_mov_b32 s94, 0
    s_cmp_eq_u64 s[0:1], 0
    s_cbranch_scc1 L_polled_23
L_poll_22:
    s_add_u32 s94, s94, 1
    s_cmp_lg_u32 s94, 4
    s_cbranch_scc1 L_poll_22_o
    buffer_store_dword v35, v2, s[16:19], s15 offen sc1
L_poll_22_o:
    s_and_b32 s0, s94, 7
    s_cselect_b32 s0, s95, s15
    buffer_load_dword v8, v9, s[16:19], s0 offen sc1
    s_cmp_gt_u32 s94, 0x40000
    s_cbranch_scc1 L_polled_23
    s_waitcnt vmcnt(0)
    v_cmp_gt_u32 s[0:1], 5, v8
    s_nop 0
    s_cmp_eq_u64 s[0:1], 0
    s_cbranch_scc0 L_poll_22
L_polled_23:
    buffer_store_dword v35, v2, s[16:19], s15 offen sc1
    s_barrier
    s_lshl_b32 s28, s3, 11
    v_add_u32 v5, s28, v1
    v_add_u32 v6, 50176, v5
    v_add_u32 v7, 100352, v5
    ds_read_b128 a[32:35], v7 offset:21504
    ds_read_b128 a[36:39], v7 offset:22528
    ds_read_b128 a[40:43], v7 offset:28672
    buffer_load_dwordx4 a[0:3], v1, s[16:19], s32 offen offset:0 sc1
    buffer_load_dwordx4 a[4:7], v13, s[16:19], s32 offen offset:0 sc1
    ds_read_b128 a[64:67], v10 offset:0
    ds_read_b128 a[68:71], v10 offset:1024
    buffer_load_dwordx4 a[8:11], v1, s[16:19], s32 offen offset:1024 sc1
    buffer_load_dwordx4 a[12:15], v13, s[16:19], s32 offen offset:1024 sc1
    ds_read_b128 a[72:75], v10 offset:2048
    ds_read_b128 a[76:79], v10 offset:3072
    buffer_load_dwordx4 a[16:19], v1, s[16:19], s32 offen offset:2048 sc1
    buffer_load_dwordx4 a[20:23], v13, s[16:19], s32 offen offset:2048 sc1
    ds_read_b128 a[80:83], v10 offset:4096
    ds_read_b128 a[84:87], v10 offset:5120
    buffer_load_dwordx4 a[24:27], v1, s[16:19], s32 offen offset:3072 sc1
    buffer_load_dwordx4 a[28:31], v13, s[16:19], s32 offen offset:3072 sc1
    s_nop 0
    ds_read_b128 a[44:47], v7 offset:29696
    s_waitcnt lgkmcnt(9)
    v_mfma_f32_16x16x32_bf16 a[52:55], a[32:35], a[48:51], a[52:55]
    ds_read_b128 a[32:35], v7 offset:35840
    s_waitcnt lgkmcnt(9)
    v_mfma_f32_16x16x32_bf16 a[56:59], a[36:39], a[48:51], a[56:59]
    ds_read_b128 a[36:39], v7 offset:36864
    s_waitcnt lgkmcnt(9)
    v_mfma_f32_16x16x32_bf16 a[52:55], a[40:43], a[48:51], a[52:55]
    s_waitcnt lgkmcnt(2)
    v_mfma_f32_16x16x32_bf16 a[56:59], a[44:47], a[48:51], a[56:59]
    s_waitcnt lgkmcnt(1)
    v_mfma_f32_16x16x32_bf16 a[52:55], a[32:35], a[48:51], a[52:55]
    s_waitcnt lgkmcnt(0)
    v_mfma_f32_16x16x32_bf16 a[56:59], a[36:39], a[48:51], a[56:59]
    buffer_load_dwordx2 v[34:35], v22, s[16:19], s25 offen sc1
    buffer_load_dwordx2 v[36:37], v22, s[16:19], s25 offen offset:512 sc1
    s_nop 3
    ds_write_b128 v23, a[52:55]
    s_nop 0
    ds_write_b128 v23, a[56:59] offset:64
    buffer_load_dwordx2 v[38:39], v22, s[16:19], s26 offen sc1
    buffer_load_dwordx2 v[40:41], v22, s[16:19], s26 offen offset:512 sc1
    s_waitcnt vmcnt(11)
    v_mfma_f32_16x16x32_bf16 v[42:45], a[64:67], a[0:3], 0
    ds_read_b128 a[88:91], v10 offset:6144
    s_waitcnt vmcnt(10)
    v_mfma_f32_16x16x32_bf16 v[70:73], a[64:67], a[4:7], 0
    buffer_load_dwordx4 a[32:35], v1, s[16:19], s33 offen offset:0 sc1
    v_mfma_f32_16x16x32_bf16 v[46:49], a[68:71], a[0:3], 0
    ds_read_b128 a[92:95], v10 offset:7168
    v_mfma_f32_16x16x32_bf16 v[74:77], a[68:71], a[4:7], 0
    buffer_load_dwordx4 v[172:175], v1, s[16:19], s40 offen offset:0 sc1
    v_mfma_f32_16x16x32_bf16 v[50:53], a[72:75], a[0:3], 0
    ds_read_b128 a[64:67], v10 offset:8192
    v_mfma_f32_16x16x32_bf16 v[78:81], a[72:75], a[4:7], 0
    v_mfma_f32_16x16x32_bf16 v[54:57], a[76:79], a[0:3], 0
    ds_read_b128 a[68:71], v10 offset:9216
    v_mfma_f32_16x16x32_bf16 v[82:85], a[76:79], a[4:7], 0
    buffer_load_dwordx4 a[36:39], v13, s[16:19], s33 offen offset:0 sc1
    v_mfma_f32_16x16x32_bf16 v[58:61], a[80:83], a[0:3], 0
    ds_read_b128 a[72:75], v10 offset:10240
    v_mfma_f32_16x16x32_bf16 v[86:89], a[80:83], a[4:7], 0
    v_mfma_f32_16x16x32_bf16 v[62:65], a[84:87], a[0:3], 0
    ds_read_b128 a[76:79], v10 offset:11264
    v_mfma_f32_16x16x32_bf16 v[90:93], a[84:87], a[4:7], 0
    buffer_load_dwordx4 a[40:43], v1, s[16:19], s34 offen offset:0 sc1
    s_waitcnt lgkmcnt(3)
    v_mfma_f32_16x16x32_bf16 v[66:69], a[88:91], a[0:3], 0
    ds_read_b128 a[80:83], v10 offset:12288
    v_mfma_f32_16x16x32_bf16 v[94:97], a[88:91], a[4:7], 0
    s_waitcnt vmcnt(12)
    v_mfma_f32_16x16x32_bf16 v[42:45], a[92:95], a[8:11], v[42:45]
    ds_read_b128 a[84:87], v10 offset:13312
    v_mfma_f32_16x16x32_bf16 v[70:73], a[92:95], a[12:15], v[70:73]
    buffer_load_dwordx4 a[44:47], v13, s[16:19], s34 offen offset:0 sc1
    v_mfma_f32_16x16x32_bf16 v[46:49], a[64:67], a[8:11], v[46:49]
    ds_read_b128 a[88:91], v10 offset:14336
    v_mfma_f32_16x16x32_bf16 v[74:77], a[64:67], a[12:15], v[74:77]
    s_waitcnt lgkmcnt(3)
    s_barrier
    v_mfma_f32_16x16x32_bf16 v[50:53], a[68:71], a[8:11], v[50:53]
    ds_read_b128 a[92:95], v10 offset:15360
    v_mfma_f32_16x16x32_bf16 v[78:81], a[68:71], a[12:15], v[78:81]
    ds_read_b128 v[128:131], v21 offset:0
    ds_read_b128 v[132:135], v21 offset:64
    v_mfma_f32_16x16x32_bf16 v[54:57], a[72:75], a[8:11], v[54:57]
    ds_read_b128 a[64:67], v10 offset:16384
    v_mfma_f32_16x16x32_bf16 v[82:85], a[72:75], a[12:15], v[82:85]
    buffer_load_dwordx4 a[48:51], v1, s[16:19], s34 offen offset:1024 sc1
    ds_read_b128 v[136:139], v21 offset:128
    v_mfma_f32_16x16x32_bf16 v[58:61], a[76:79], a[8:11], v[58:61]
    ds_read_b128 a[68:71], v10 offset:17408
    v_mfma_f32_16x16x32_bf16 v[86:89], a[76:79], a[12:15], v[86:89]
    s_waitcnt lgkmcnt(6)
    ds_read_b128 v[140:143], v21 offset:192
    v_mfma_f32_16x16x32_bf16 v[62:65], a[80:83], a[8:11], v[62:65]
    ds_read_b128 a[72:75], v10 offset:18432
    v_mfma_f32_16x16x32_bf16 v[90:93], a[80:83], a[12:15], v[90:93]
    buffer_load_dwordx4 a[52:55], v13, s[16:19], s34 offen offset:1024 sc1
    ds_read_b128 v[144:147], v21 offset:256
    v_mfma_f32_16x16x32_bf16 v[66:69], a[84:87], a[8:11], v[66:69]
    ds_read_b128 a[76:79], v10 offset:19456
    v_mfma_f32_16x16x32_bf16 v[94:97], a[84:87], a[12:15], v[94:97]
    s_waitcnt vmcnt(13)
    ds_read_b128 v[148:151], v21 offset:320
    v_mfma_f32_16x16x32_bf16 v[42:45], a[88:91], a[16:19], v[42:45]
    ds_read_b128 a[80:83], v10 offset:20480
    v_mfma_f32_16x16x32_bf16 v[70:73], a[88:91], a[20:23], v[70:73]
    buffer_load_dwordx4 a[56:59], v1, s[16:19], s34 offen offset:2048 sc1
    s_waitcnt lgkmcnt(6)
    v_mfma_f32_16x16x32_bf16 v[46:49], a[92:95], a[16:19], v[46:49]
    ds_read_b128 a[84:87], v10 offset:21504
    v_mfma_f32_16x16x32_bf16 v[74:77], a[92:95], a[20:23], v[74:77]
    buffer_load_dwordx4 v[176:179], v1, s[16:19], s40 offen offset:1024 sc1
    ds_read_b128 v[152:155], v21 offset:384
    v_mfma_f32_16x16x32_bf16 v[50:53], a[64:67], a[16:19], v[50:53]
    ds_read_b128 a[88:91], v10 offset:22528
    v_mfma_f32_16x16x32_bf16 v[78:81], a[64:67], a[20:23], v[78:81]
    s_waitcnt vmcnt(11)
    v_add_f32 v34, v34, v36
    v_mfma_f32_16x16x32_bf16 v[54:57], a[68:71], a[16:19], v[54:57]
    ds_read_b128 a[92:95], v10 offset:23552
    v_mfma_f32_16x16x32_bf16 v[82:85], a[68:71], a[20:23], v[82:85]
    buffer_load_dwordx4 a[60:63], v13, s[16:19], s34 offen offset:2048 sc1
    s_waitcnt lgkmcnt(4)
    v_mfma_f32_16x16x32_bf16 v[58:61], a[72:75], a[16:19], v[58:61]
    ds_read_b128 a[64:67], v10 offset:24576
    v_mfma_f32_16x16x32_bf16 v[86:89], a[72:75], a[20:23], v[86:89]
    v_add_f32 v35, v35, v37
    v_mov_b32 v36, v34
    v_mfma_f32_16x16x32_bf16 v[62:65], a[76:79], a[16:19], v[62:65]
    ds_read_b128 a[68:71], v10 offset:25600
    v_mfma_f32_16x16x32_bf16 v[90:93], a[76:79], a[20:23], v[90:93]
    buffer_load_dwordx4 a[0:3], v1, s[16:19], s34 offen offset:3072 sc1
    v_mov_b32 v37, v35
    v_mfma_f32_16x16x32_bf16 v[66:69], a[80:83], a[16:19], v[66:69]
    ds_read_b128 a[72:75], v10 offset:26624
    v_mfma_f32_16x16x32_bf16 v[94:97], a[80:83], a[20:23], v[94:97]
    s_waitcnt lgkmcnt(3)
    v_permlane16_swap_b32 v34, v36
    v_mfma_f32_16x16x32_bf16 v[42:45], a[84:87], a[24:27], v[42:45]
    ds_read_b128 a[76:79], v10 offset:27648
    v_mfma_f32_16x16x32_bf16 v[70:73], a[84:87], a[28:31], v[70:73]
    buffer_load_dwordx4 a[4:7], v13, s[16:19], s34 offen offset:3072 sc1
    v_permlane16_swap_b32 v35, v37
    v_mfma_f32_16x16x32_bf16 v[46:49], a[88:91], a[24:27], v[46:49]
    ds_read_b128 a[80:83], v10 offset:28672
    v_mfma_f32_16x16x32_bf16 v[74:77], a[88:91], a[28:31], v[74:77]
    v_add_f32 v34, v34, v36
    v_add_f32 v35, v35, v37
    v_mfma_f32_16x16x32_bf16 v[50:53], a[92:95], a[24:27], v[50:53]
    ds_read_b128 a[84:87], v10 offset:29696
    v_mfma_f32_16x16x32_bf16 v[78:81], a[92:95], a[28:31], v[78:81]
    s_waitcnt lgkmcnt(3)
    v_mov_b32 v36, v34
    v_mfma_f32_16x16x32_bf16 v[54:57], a[64:67], a[24:27], v[54:57]
    ds_read_b128 a[88:91], v10 offset:30720
    v_mfma_f32_16x16x32_bf16 v[82:85], a[64:67], a[28:31], v[82:85]
    buffer_load_dwordx4 a[8:11], v1, s[16:19], s35 offen offset:0 sc1
    v_mov_b32 v37, v35
    v_mfma_f32_16x16x32_bf16 v[58:61], a[68:71], a[24:27], v[58:61]
    ds_read_b128 a[92:95], v10 offset:31744
    v_mfma_f32_16x16x32_bf16 v[86:89], a[68:71], a[28:31], v[86:89]
    v_permlane32_swap_b32 v34, v36
    v_permlane32_swap_b32 v35, v37
    v_mfma_f32_16x16x32_bf16 v[62:65], a[72:75], a[24:27], v[62:65]
    ds_read_b128 a[64:67], v10 offset:32768
    v_mfma_f32_16x16x32_bf16 v[90:93], a[72:75], a[28:31], v[90:93]
    buffer_load_dwordx4 a[12:15], v13, s[16:19], s35 offen offset:0 sc1
    s_waitcnt lgkmcnt(3)
    v_mfma_f32_16x16x32_bf16 v[66:69], a[76:79], a[24:27], v[66:69]
    ds_read_b128 a[68:71], v10 offset:33792
    v_mfma_f32_16x16x32_bf16 v[94:97], a[76:79], a[28:31], v[94:97]
    s_waitcnt vmcnt(11)
    v_add_f32 v34, v34, v36
    v_mfma_f32_16x16x32_bf16 v[42:45], a[80:83], a[32:35], v[42:45]
    ds_read_b128 a[72:75], v10 offset:34816
    v_mfma_f32_16x16x32_bf16 v[70:73], a[80:83], a[36:39], v[70:73]
    buffer_load_dwordx4 a[16:19], v1, s[16:19], s36 offen offset:0 sc1
    v_add_f32 v35, v35, v37
    v_mfma_f32_16x16x32_bf16 v[46:49], a[84:87], a[32:35], v[46:49]
    ds_read_b128 a[76:79], v10 offset:35840
    v_mfma_f32_16x16x32_bf16 v[74:77], a[84:87], a[36:39], v[74:77]
    buffer_load_dwordx4 v[180:183], v1, s[16:19], s40 offen offset:2048 sc1
    s_waitcnt lgkmcnt(3)
    v_mfma_f32_16x16x32_bf16 v[50:53], a[88:91], a[32:35], v[50:53]
    ds_read_b128 a[80:83], v10 offset:36864
    v_mfma_f32_16x16x32_bf16 v[78:81], a[88:91], a[36:39], v[78:81]
    v_mov_b32 v36, v35
    v_mul_f32 v34, 0x3acccccd, v34
    v_mfma_f32_16x16x32_bf16 v[54:57], a[92:95], a[32:35], v[54:57]
    ds_read_b128 a[84:87], v10 offset:37888
    v_mfma_f32_16x16x32_bf16 v[82:85], a[92:95], a[36:39], v[82:85]
    buffer_load_dwordx4 a[20:23], v13, s[16:19], s36 offen offset:0 sc1
    v_mul_f32 v36, 0x3acccccd, v36
    v_mfma_f32_16x16x32_bf16 v[58:61], a[64:67], a[32:35], v[58:61]
    ds_read_b128 a[88:91], v10 offset:38912
    v_mfma_f32_16x16x32_bf16 v[86:89], a[64:67], a[36:39], v[86:89]
    s_waitcnt lgkmcnt(3)
    v_fma_f32 v36, -v34, v34, v36
    v_mfma_f32_16x16x32_bf16 v[62:65], a[68:71], a[32:35], v[62:65]
    ds_read_b128 a[92:95], v10 offset:39936
    v_mfma_f32_16x16x32_bf16 v[90:93], a[68:71], a[36:39], v[90:93]
    buffer_load_dwordx4 a[24:27], v1, s[16:19], s36 offen offset:1024 sc1
    v_max_f32 v36, 0, v36
    v_mfma_f32_16x16x32_bf16 v[66:69], a[72:75], a[32:35], v[66:69]
    ds_read_b128 a[64:67], v10 offset:40960
    v_mfma_f32_16x16x32_bf16 v[94:97], a[72:75], a[36:39], v[94:97]
    s_waitcnt vmcnt(13)
    v_add_f32 v36, 0x3727c5ac, v36
    v_mfma_f32_16x16x32_bf16 v[42:45], a[76:79], a[40:43], v[42:45]
    ds_read_b128 a[68:71], v10 offset:41984
    v_mfma_f32_16x16x32_bf16 v[70:73], a[76:79], a[44:47], v[70:73]
    buffer_load_dwordx4 a[28:31], v13, s[16:19], s36 offen offset:1024 sc1
    s_waitcnt lgkmcnt(3)
    v_mfma_f32_16x16x32_bf16 v[46:49], a[80:83], a[40:43], v[46:49]
    ds_read_b128 a[72:75], v10 offset:43008
    v_mfma_f32_16x16x32_bf16 v[74:77], a[80:83], a[44:47], v[74:77]
    v_rsq_f32 v35, v36
    s_nop 0
    v_mul_f32_e64 v36, -v34, v35
    v_mfma_f32_16x16x32_bf16 v[50:53], a[84:87], a[40:43], v[50:53]
    ds_read_b128 a[76:79], v10 offset:44032
    v_mfma_f32_16x16x32_bf16 v[78:81], a[84:87], a[44:47], v[78:81]
    v_mov_b32 v34, v35
    v_add_f32 v38, v38, v40
    v_mfma_f32_16x16x32_bf16 v[54:57], a[88:91], a[40:43], v[54:57]
    ds_read_b128 a[80:83], v10 offset:45056
    v_mfma_f32_16x16x32_bf16 v[82:85], a[88:91], a[44:47], v[82:85]
    buffer_load_dwordx4 a[32:35], v1, s[16:19], s36 offen offset:2048 sc1
    s_waitcnt lgkmcnt(3)
    v_mfma_f32_16x16x32_bf16 v[58:61], a[92:95], a[40:43], v[58:61]
    ds_read_b128 a[84:87], v10 offset:46080
    v_mfma_f32_16x16x32_bf16 v[86:89], a[92:95], a[44:47], v[86:89]
    v_add_f32 v39, v39, v41
    v_mov_b32 v40, v38
    v_mfma_f32_16x16x32_bf16 v[62:65], a[64:67], a[40:43], v[62:65]
    ds_read_b128 a[88:91], v10 offset:47104
    v_mfma_f32_16x16x32_bf16 v[90:93], a[64:67], a[44:47], v[90:93]
    buffer_load_dwordx4 a[36:39], v13, s[16:19], s36 offen offset:2048 sc1
    v_mov_b32 v41, v39
    v_mfma_f32_16x16x32_bf16 v[66:69], a[68:71], a[40:43], v[66:69]
    ds_read_b128 a[92:95], v10 offset:48128
    v_mfma_f32_16x16x32_bf16 v[94:97], a[68:71], a[44:47], v[94:97]
    s_waitcnt lgkmcnt(3)
    s_waitcnt vmcnt(14)
    v_mfma_f32_16x16x32_bf16 v[42:45], a[72:75], a[48:51], v[42:45]
    ds_read_b128 a[64:67], v10 offset:49152
    v_mfma_f32_16x16x32_bf16 v[70:73], a[72:75], a[52:55], v[70:73]
    buffer_load_dwordx4 a[40:43], v1, s[16:19], s36 offen offset:3072 sc1
    v_permlane16_swap_b32 v38, v40
    v_mfma_f32_16x16x32_bf16 v[46:49], a[76:79], a[48:51], v[46:49]
    ds_read_b128 a[68:71], v11 offset:0
    v_mfma_f32_16x16x32_bf16 v[74:77], a[76:79], a[52:55], v[74:77]
    buffer_load_dwordx4 v[184:187], v1, s[16:19], s40 offen offset:3072 sc1
    s_add_u32 s40, s40, 4096
    v_mfma_f32_16x16x32_bf16 v[50:53], a[80:83], a[48:51], v[50:53]
    ds_read_b128 a[72:75], v11 offset:1024
    v_mfma_f32_16x16x32_bf16 v[78:81], a[80:83], a[52:55], v[78:81]
    s_waitcnt lgkmcnt(3)
    v_permlane16_swap_b32 v39, v41
    v_mfma_f32_16x16x32_bf16 v[54:57], a[84:87], a[48:51], v[54:57]
    ds_read_b128 a[76:79], v11 offset:2048
    v_mfma_f32_16x16x32_bf16 v[82:85], a[84:87], a[52:55], v[82:85]
    buffer_load_dwordx4 a[44:47], v13, s[16:19], s36 offen offset:3072 sc1
    v_add_f32 v38, v38, v40
    v_mfma_f32_16x16x32_bf16 v[58:61], a[88:91], a[48:51], v[58:61]
    ds_read_b128 a[80:83], v11 offset:3072
    v_mfma_f32_16x16x32_bf16 v[86:89], a[88:91], a[52:55], v[86:89]
    v_add_f32 v39, v39, v41
    v_mov_b32 v40, v38
    v_mfma_f32_16x16x32_bf16 v[62:65], a[92:95], a[48:51], v[62:65]
    ds_read_b128 a[84:87], v11 offset:4096
    v_mfma_f32_16x16x32_bf16 v[90:93], a[92:95], a[52:55], v[90:93]
    s_waitcnt lgkmcnt(3)
    v_mov_b32 v41, v39
    v_mfma_f32_16x16x32_bf16 v[66:69], a[64:67], a[48:51], v[66:69]
    ds_read_b128 a[88:91], v11 offset:5120
    v_mfma_f32_16x16x32_bf16 v[94:97], a[64:67], a[52:55], v[94:97]
    s_waitcnt vmcnt(14)
    v_permlane32_swap_b32 v38, v40
    v_mfma_f32_16x16x32_bf16 v[42:45], a[68:71], a[56:59], v[42:45]
    ds_read_b128 a[92:95], v11 offset:6144
    v_mfma_f32_16x16x32_bf16 v[70:73], a[68:71], a[60:63], v[70:73]
    buffer_load_dwordx4 a[48:51], v1, s[16:19], s37 offen offset:0 sc1
    v_permlane32_swap_b32 v39, v41
    v_mfma_f32_16x16x32_bf16 v[46:49], a[72:75], a[56:59], v[46:49]
    ds_read_b128 a[64:67], v11 offset:7168
    v_mfma_f32_16x16x32_bf16 v[74:77], a[72:75], a[60:63], v[74:77]
    s_waitcnt lgkmcnt(3)
    v_add_f32 v38, v38, v40
    v_mfma_f32_16x16x32_bf16 v[50:53], a[76:79], a[56:59], v[50:53]
    ds_read_b128 a[68:71], v11 offset:8192
    v_mfma_f32_16x16x32_bf16 v[78:81], a[76:79], a[60:63], v[78:81]
    v_add_f32 v39, v39, v41
    v_mov_b32 v40, v39
    v_mfma_f32_16x16x32_bf16 v[54:57], a[80:83], a[56:59], v[54:57]
    ds_read_b128 a[72:75], v11 offset:9216
    v_mfma_f32_16x16x32_bf16 v[82:85], a[80:83], a[60:63], v[82:85]
    buffer_load_dwordx4 a[52:55], v13, s[16:19], s37 offen offset:0 sc1
    v_mul_f32 v38, 0x3acccccd, v38
    v_mfma_f32_16x16x32_bf16 v[58:61], a[84:87], a[56:59], v[58:61]
    ds_read_b128 a[76:79], v11 offset:10240
    v_mfma_f32_16x16x32_bf16 v[86:89], a[84:87], a[60:63], v[86:89]
    s_waitcnt lgkmcnt(3)
    v_mul_f32 v40, 0x3acccccd, v40
    v_mfma_f32_16x16x32_bf16 v[62:65], a[88:91], a[56:59], v[62:65]
    ds_read_b128 a[80:83], v11 offset:11264
    v_mfma_f32_16x16x32_bf16 v[90:93], a[88:91], a[60:63], v[90:93]
    v_fma_f32 v40, -v38, v38, v40
    v_max_f32 v40, 0, v40
    v_mfma_f32_16x16x32_bf16 v[66:69], a[92:95], a[56:59], v[66:69]
    ds_read_b128 a[84:87], v11 offset:12288
    v_mfma_f32_16x16x32_bf16 v[94:97], a[92:95], a[60:63], v[94:97]
    s_waitcnt vmcnt(14)
    v_add_f32 v40, 0x3727c5ac, v40
    v_mfma_f32_16x16x32_bf16 v[42:45], a[64:67], a[0:3], v[42:45]
    ds_read_b128 a[88:91], v11 offset:13312
    v_mfma_f32_16x16x32_bf16 v[70:73], a[64:67], a[4:7], v[70:73]
    buffer_load_dwordx4 a[56:59], v1, s[16:19], s38 offen offset:0 sc1
    s_waitcnt lgkmcnt(3)
    v_mfma_f32_16x16x32_bf16 v[46:49], a[68:71], a[0:3], v[46:49]
    ds_read_b128 a[92:95], v11 offset:14336
    v_mfma_f32_16x16x32_bf16 v[74:77], a[68:71], a[4:7], v[74:77]
    buffer_load_dwordx4 v[188:191], v1, s[16:19], s40 offen offset:0 sc1
    v_rsq_f32 v39, v40
    v_mfma_f32_16x16x32_bf16 v[50:53], a[72:75], a[0:3], v[50:53]
    ds_read_b128 a[64:67], v11 offset:15360
    v_mfma_f32_16x16x32_bf16 v[78:81], a[72:75], a[4:7], v[78:81]
    v_mul_f32_e64 v40, -v38, v39
    v_mov_b32 v38, v39
    v_mfma_f32_16x16x32_bf16 v[54:57], a[76:79], a[0:3], v[54:57]
    ds_read_b128 a[68:71], v11 offset:16384
    v_mfma_f32_16x16x32_bf16 v[82:85], a[76:79], a[4:7], v[82:85]
    buffer_load_dwordx4 a[60:63], v13, s[16:19], s38 offen offset:0 sc1
    s_waitcnt lgkmcnt(3)
    v_mfma_f32_16x16x32_bf16 v[58:61], a[80:83], a[0:3], v[58:61]
    ds_read_b128 a[72:75], v11 offset:17408
    v_mfma_f32_16x16x32_bf16 v[86:89], a[80:83], a[4:7], v[86:89]
    v_fma_f32 v98, v128, v36, v100
    v_fma_f32 v128, v128, v40, v100
    v_mfma_f32_16x16x32_bf16 v[62:65], a[84:87], a[0:3], v[62:65]
    ds_read_b128 a[76:79], v11 offset:18432
    v_mfma_f32_16x16x32_bf16 v[90:93], a[84:87], a[4:7], v[90:93]
    v_fma_f32 v99, v129, v36, v101
    v_fma_f32 v129, v129, v40, v101
    v_mfma_f32_16x16x32_bf16 v[66:69], a[88:91], a[0:3], v[66:69]
    ds_read_b128 a[80:83], v11 offset:19456
    v_mfma_f32_16x16x32_bf16 v[94:97], a[88:91], a[4:7], v[94:97]
    s_waitcnt lgkmcnt(3)
    s_waitcnt vmcnt(15)
    v_mfma_f32_16x16x32_bf16 v[42:45], a[92:95], a[8:11], v[42:45]
    ds_read_b128 a[84:87], v11 offset:20480
    v_mfma_f32_16x16x32_bf16 v[70:73], a[92:95], a[12:15], v[70:73]
    buffer_load_dwordx4 a[0:3], v1, s[16:19], s38 offen offset:1024 sc1
    v_fma_f32 v100, v130, v36, v102
    v_mfma_f32_16x16x32_bf16 v[46:49], a[64:67], a[8:11], v[46:49]
    ds_read_b128 a[88:91], v11 offset:21504
    v_mfma_f32_16x16x32_bf16 v[74:77], a[64:67], a[12:15], v[74:77]
    v_fma_f32 v130, v130, v40, v102
    v_fma_f32 v101, v131, v36, v103
    v_mfma_f32_16x16x32_bf16 v[50:53], a[68:71], a[8:11], v[50:53]
    ds_read_b128 a[92:95], v11 offset:22528
    v_mfma_f32_16x16x32_bf16 v[78:81], a[68:71], a[12:15], v[78:81]
    s_waitcnt lgkmcnt(3)
    v_fma_f32 v131, v131, v40, v103
    v_mfma_f32_16x16x32_bf16 v[54:57], a[72:75], a[8:11], v[54:57]
    ds_read_b128 a[64:67], v11 offset:23552
    v_mfma_f32_16x16x32_bf16 v[82:85], a[72:75], a[12:15], v[82:85]
    buffer_load_dwordx4 a[4:7], v13, s[16:19], s38 offen offset:1024 sc1
    v_fma_f32 v102, v132, v36, v104
    v_mfma_f32_16x16x32_bf16 v[58:61], a[76:79], a[8:11], v[58:61]
    ds_read_b128 a[68:71], v11 offset:24576
    v_mfma_f32_16x16x32_bf16 v[86:89], a[76:79], a[12:15], v[86:89]
    v_fma_f32 v132, v132, v40, v104
    v_fma_f32 v103, v133, v36, v105
    v_mfma_f32_16x16x32_bf16 v[62:65], a[80:83], a[8:11], v[62:65]
    ds_read_b128 a[72:75], v11 offset:25600
    v_mfma_f32_16x16x32_bf16 v[90:93], a[80:83], a[12:15], v[90:93]
    s_waitcnt lgkmcnt(3)
    v_fma_f32 v133, v133, v40, v105
    v_mfma_f32_16x16x32_bf16 v[66:69], a[84:87], a[8:11], v[66:69]
    ds_read_b128 a[76:79], v11 offset:26624
    v_mfma_f32_16x16x32_bf16 v[94:97], a[84:87], a[12:15], v[94:97]
    s_waitcnt vmcnt(14)
    v_fma_f32 v104, v134, v36, v106
    v_mfma_f32_16x16x32_bf16 v[42:45], a[88:91], a[16:19], v[42:45]
    ds_read_b128 a[80:83], v11 offset:27648
    v_mfma_f32_16x16x32_bf16 v[70:73], a[88:91], a[20:23], v[70:73]
    buffer_load_dwordx4 a[8:11], v1, s[16:19], s38 offen offset:2048 sc1
    v_fma_f32 v134, v134, v40, v106
    v_mfma_f32_16x16x32_bf16 v[46:49], a[92:95], a[16:19], v[46:49]
    ds_read_b128 a[84:87], v11 offset:28672
    v_mfma_f32_16x16x32_bf16 v[74:77], a[92:95], a[20:23], v[74:77]
    buffer_load_dwordx4 v[192:195], v1, s[16:19], s40 offen offset:1024 sc1
    s_waitcnt lgkmcnt(3)
    v_mfma_f32_16x16x32_bf16 v[50:53], a[64:67], a[16:19], v[50:53]
    ds_read_b128 a[88:91], v11 offset:29696
    v_mfma_f32_16x16x32_bf16 v[78:81], a[64:67], a[20:23], v[78:81]
    v_fma_f32 v105, v135, v36, v107
    v_fma_f32 v135, v135, v40, v107
    v_mfma_f32_16x16x32_bf16 v[54:57], a[68:71], a[16:19], v[54:57]
    ds_read_b128 a[92:95], v11 offset:30720
    v_mfma_f32_16x16x32_bf16 v[82:85], a[68:71], a[20:23], v[82:85]
    buffer_load_dwordx4 a[12:15], v13, s[16:19], s38 offen offset:2048 sc1
    v_fma_f32 v106, v136, v36, v108
    v_mfma_f32_16x16x32_bf16 v[58:61], a[72:75], a[16:19], v[58:61]
    ds_read_b128 a[64:67], v11 offset:31744
    v_mfma_f32_16x16x32_bf16 v[86:89], a[72:75], a[20:23], v[86:89]
    s_waitcnt lgkmcnt(3)
    v_fma_f32 v136, v136, v40, v108
    v_mfma_f32_16x16x32_bf16 v[62:65], a[76:79], a[16:19], v[62:65]
    ds_read_b128 a[68:71], v11 offset:32768
    v_mfma_f32_16x16x32_bf16 v[90:93], a[76:79], a[20:23], v[90:93]
    v_fma_f32 v107, v137, v36, v109
    v_fma_f32 v137, v137, v40, v109
    v_mfma_f32_16x16x32_bf16 v[66:69], a[80:83], a[16:19], v[66:69]
    ds_read_b128 a[72:75], v11 offset:33792
    v_mfma_f32_16x16x32_bf16 v[94:97], a[80:83], a[20:23], v[94:97]
    s_waitcnt vmcnt(15)
    v_fma_f32 v108, v138, v36, v110
    v_mfma_f32_16x16x32_bf16 v[42:45], a[84:87], a[24:27], v[42:45]
    ds_read_b128 a[76:79], v11 offset:34816
    v_mfma_f32_16x16x32_bf16 v[70:73], a[84:87], a[28:31], v[70:73]
    buffer_load_dwordx4 a[16:19], v1, s[16:19], s38 offen offset:3072 sc1
    s_waitcnt lgkmcnt(3)
    v_mfma_f32_16x16x32_bf16 v[46:49], a[88:91], a[24:27], v[46:49]
    ds_read_b128 a[80:83], v11 offset:35840
    v_mfma_f32_16x16x32_bf16 v[74:77], a[88:91], a[28:31], v[74:77]
    v_fma_f32 v138, v138, v40, v110
    v_fma_f32 v109, v139, v36, v111
    v_mfma_f32_16x16x32_bf16 v[50:53], a[92:95], a[24:27], v[50:53]
    ds_read_b128 a[84:87], v11 offset:36864
    v_mfma_f32_16x16x32_bf16 v[78:81], a[92:95], a[28:31], v[78:81]
    v_fma_f32 v139, v139, v40, v111
    v_fma_f32 v110, v140, v36, v112
    v_mfma_f32_16x16x32_bf16 v[54:57], a[64:67], a[24:27], v[54:57]
    ds_read_b128 a[88:91], v11 offset:37888
    v_mfma_f32_16x16x32_bf16 v[82:85], a[64:67], a[28:31], v[82:85]
    buffer_load_dwordx4 a[20:23], v13, s[16:19], s38 offen offset:3072 sc1
    s_waitcnt lgkmcnt(3)
    v_mfma_f32_16x16x32_bf16 v[58:61], a[68:71], a[24:27], v[58:61]
    ds_read_b128 a[92:95], v11 offset:38912
    v_mfma_f32_16x16x32_bf16 v[86:89], a[68:71], a[28:31], v[86:89]
    v_fma_f32 v140, v140, v40, v112
    v_fma_f32 v111, v141, v36, v113
    v_mfma_f32_16x16x32_bf16 v[62:65], a[72:75], a[24:27], v[62:65]
    ds_read_b128 a[64:67], v11 offset:39936
    v_mfma_f32_16x16x32_bf16 v[90:93], a[72:75], a[28:31], v[90:93]
    v_fma_f32 v141, v141, v40, v113
    v_fma_f32 v112, v142, v36, v114
    v_mfma_f32_16x16x32_bf16 v[66:69], a[76:79], a[24:27], v[66:69]
    ds_read_b128 a[68:71], v11 offset:40960
    v_mfma_f32_16x16x32_bf16 v[94:97], a[76:79], a[28:31], v[94:97]
    s_waitcnt lgkmcnt(3)
    s_waitcnt vmcnt(15)
    v_mfma_f32_16x16x32_bf16 v[42:45], a[80:83], a[32:35], v[42:45]
    ds_read_b128 a[72:75], v11 offset:41984
    v_mfma_f32_16x16x32_bf16 v[70:73], a[80:83], a[36:39], v[70:73]
    buffer_load_dwordx4 a[24:27], v1, s[16:19], s39 offen offset:0 sc1
    v_fma_f32 v142, v142, v40, v114
    v_mfma_f32_16x16x32_bf16 v[46:49], a[84:87], a[32:35], v[46:49]
    ds_read_b128 a[76:79], v11 offset:43008
    v_mfma_f32_16x16x32_bf16 v[74:77], a[84:87], a[36:39], v[74:77]
    buffer_load_dwordx4 v[196:199], v1, s[16:19], s40 offen offset:2048 sc1
    v_fma_f32 v113, v143, v36, v115
    v_mfma_f32_16x16x32_bf16 v[50:53], a[88:91], a[32:35], v[50:53]
    ds_read_b128 a[80:83], v11 offset:44032
    v_mfma_f32_16x16x32_bf16 v[78:81], a[88:91], a[36:39], v[78:81]
    s_waitcnt lgkmcnt(3)
    v_fma_f32 v143, v143, v40, v115
    v_mfma_f32_16x16x32_bf16 v[54:57], a[92:95], a[32:35], v[54:57]
    ds_read_b128 a[84:87], v11 offset:45056
    v_mfma_f32_16x16x32_bf16 v[82:85], a[92:95], a[36:39], v[82:85]
    buffer_load_dwordx4 a[28:31], v13, s[16:19], s39 offen offset:0 sc1
    v_fma_f32 v114, v144, v36, v116
    v_mfma_f32_16x16x32_bf16 v[58:61], a[64:67], a[32:35], v[58:61]
    ds_read_b128 a[88:91], v11 offset:46080
    v_mfma_f32_16x16x32_bf16 v[86:89], a[64:67], a[36:39], v[86:89]
    buffer_load_dwordx4 v[200:203], v1, s[16:19], s40 offen offset:3072 sc1
    s_add_u32 s40, s40, 4096
    v_mfma_f32_16x16x32_bf16 v[62:65], a[68:71], a[32:35], v[62:65]
    ds_read_b128 a[92:95], v11 offset:47104
    v_mfma_f32_16x16x32_bf16 v[90:93], a[68:71], a[36:39], v[90:93]
    s_waitcnt lgkmcnt(3)
    v_fma_f32 v144, v144, v40, v116
    v_mfma_f32_16x16x32_bf16 v[66:69], a[72:75], a[32:35], v[66:69]
    ds_read_b128 a[64:67], v11 offset:48128
    v_mfma_f32_16x16x32_bf16 v[94:97], a[72:75], a[36:39], v[94:97]
    buffer_load_dwordx4 v[204:207], v1, s[16:19], s40 offen offset:0 sc1
    s_waitcnt vmcnt(17)
    v_mfma_f32_16x16x32_bf16 v[42:45], a[76:79], a[40:43], v[42:45]
    ds_read_b128 a[68:71], v11 offset:49152
    v_mfma_f32_16x16x32_bf16 v[70:73], a[76:79], a[44:47], v[70:73]
    v_fma_f32 v115, v145, v36, v117
    v_fma_f32 v145, v145, v40, v117
    v_mfma_f32_16x16x32_bf16 v[46:49], a[80:83], a[40:43], v[46:49]
    ds_read_b128 a[72:75], v12 offset:0
    v_mfma_f32_16x16x32_bf16 v[74:77], a[80:83], a[44:47], v[74:77]
    buffer_load_dwordx4 v[208:211], v1, s[16:19], s40 offen offset:1024 sc1
    s_waitcnt lgkmcnt(3)
    v_mfma_f32_16x16x32_bf16 v[50:53], a[84:87], a[40:43], v[50:53]
    ds_read_b128 a[76:79], v12 offset:1024
    v_mfma_f32_16x16x32_bf16 v[78:81], a[84:87], a[44:47], v[78:81]
    v_fma_f32 v116, v146, v36, v118
    v_fma_f32 v146, v146, v40, v118
    v_mfma_f32_16x16x32_bf16 v[54:57], a[88:91], a[40:43], v[54:57]
    ds_read_b128 a[80:83], v12 offset:7168
    v_mfma_f32_16x16x32_bf16 v[82:85], a[88:91], a[44:47], v[82:85]
    buffer_load_dwordx4 v[212:215], v1, s[16:19], s40 offen offset:2048 sc1
    v_fma_f32 v117, v147, v36, v119
    v_mfma_f32_16x16x32_bf16 v[58:61], a[92:95], a[40:43], v[58:61]
    ds_read_b128 a[84:87], v12 offset:8192
    v_mfma_f32_16x16x32_bf16 v[86:89], a[92:95], a[44:47], v[86:89]
    s_waitcnt lgkmcnt(3)
    v_fma_f32 v147, v147, v40, v119
    v_mfma_f32_16x16x32_bf16 v[62:65], a[64:67], a[40:43], v[62:65]
    ds_read_b128 a[88:91], v12 offset:14336
    v_mfma_f32_16x16x32_bf16 v[90:93], a[64:67], a[44:47], v[90:93]
    buffer_load_dwordx4 v[216:219], v1, s[16:19], s40 offen offset:3072 sc1
    s_add_u32 s40, s40, 4096
    v_mfma_f32_16x16x32_bf16 v[66:69], a[68:71], a[40:43], v[66:69]
    ds_read_b128 a[92:95], v12 offset:15360
    v_mfma_f32_16x16x32_bf16 v[94:97], a[68:71], a[44:47], v[94:97]
    s_waitcnt vmcnt(18)
    v_fma_f32 v118, v148, v36, v120
    v_mfma_f32_16x16x32_bf16 v[42:45], a[72:75], a[48:51], v[42:45]
    ds_read_b128 a[64:67], v12 offset:21504
    v_fma_f32 v148, v148, v40, v120
    v_fma_f32 v119, v149, v36, v121
    v_fma_f32 v149, v149, v40, v121
    v_mfma_f32_16x16x32_bf16 v[70:73], a[72:75], a[52:55], v[70:73]
    buffer_load_dwordx4 v[220:223], v1, s[16:19], s40 offen offset:0 sc1
    s_waitcnt lgkmcnt(3)
    v_fma_f32 v120, v150, v36, v122
    v_fma_f32 v150, v150, v40, v122
    v_mfma_f32_16x16x32_bf16 v[46:49], a[76:79], a[48:51], v[46:49]
    ds_read_b128 a[68:71], v12 offset:22528
    v_fma_f32 v121, v151, v36, v123
    v_fma_f32 v151, v151, v40, v123
    v_fma_f32 v122, v152, v36, v124
    v_mfma_f32_16x16x32_bf16 v[74:77], a[76:79], a[52:55], v[74:77]
    s_waitcnt vmcnt(16)
    v_fma_f32 v152, v152, v40, v124
    v_fma_f32 v123, v153, v36, v125
    v_fma_f32 v153, v153, v40, v125
    v_mfma_f32_16x16x32_bf16 v[42:45], a[80:83], a[56:59], v[42:45]
    ds_read_b128 a[72:75], v12 offset:28672
    v_fma_f32 v124, v154, v36, v126
    v_fma_f32 v154, v154, v40, v126
    v_fma_f32 v125, v155, v36, v127
    v_mfma_f32_16x16x32_bf16 v[70:73], a[80:83], a[60:63], v[70:73]
    buffer_load_dwordx4 v[224:227], v1, s[16:19], s40 offen offset:1024 sc1
    v_fma_f32 v155, v155, v40, v127
    v_mfma_f32_16x16x32_bf16 v[46:49], a[84:87], a[56:59], v[46:49]
    ds_read_b128 a[76:79], v12 offset:29696
    v_mfma_f32_16x16x32_bf16 v[74:77], a[84:87], a[60:63], v[74:77]
    s_waitcnt lgkmcnt(3)
    s_waitcnt vmcnt(15)
    v_mfma_f32_16x16x32_bf16 v[42:45], a[88:91], a[0:3], v[42:45]
    ds_read_b128 a[80:83], v12 offset:35840
    v_mfma_f32_16x16x32_bf16 v[70:73], a[88:91], a[4:7], v[70:73]
    buffer_load_dwordx4 v[228:231], v1, s[16:19], s40 offen offset:2048 sc1
    v_mfma_f32_16x16x32_bf16 v[46:49], a[92:95], a[0:3], v[46:49]
    ds_read_b128 a[84:87], v12 offset:36864
    v_mfma_f32_16x16x32_bf16 v[74:77], a[92:95], a[4:7], v[74:77]
    s_waitcnt vmcnt(13)
    v_mfma_f32_16x16x32_bf16 v[42:45], a[64:67], a[8:11], v[42:45]
    ds_read_b128 a[88:91], v12 offset:2048
    v_mfma_f32_16x16x32_bf16 v[70:73], a[64:67], a[12:15], v[70:73]
    buffer_load_dwordx4 v[232:235], v1, s[16:19], s40 offen offset:3072 sc1
    s_add_u32 s40, s40, 4096
    s_waitcnt lgkmcnt(3)
    v_mfma_f32_16x16x32_bf16 v[46:49], a[68:71], a[8:11], v[46:49]
    ds_read_b128 a[92:95], v12 offset:3072
    v_mfma_f32_16x16x32_bf16 v[74:77], a[68:71], a[12:15], v[74:77]
    s_waitcnt vmcnt(12)
    v_mfma_f32_16x16x32_bf16 v[42:45], a[72:75], a[16:19], v[42:45]
    ds_read_b128 a[64:67], v12 offset:9216
    v_mfma_f32_16x16x32_bf16 v[70:73], a[72:75], a[20:23], v[70:73]
    buffer_load_dwordx4 v[236:239], v1, s[16:19], s40 offen offset:0 sc1
    v_mfma_f32_16x16x32_bf16 v[46:49], a[76:79], a[16:19], v[46:49]
    ds_read_b128 a[68:71], v12 offset:10240
    v_mfma_f32_16x16x32_bf16 v[74:77], a[76:79], a[20:23], v[74:77]
    s_waitcnt lgkmcnt(3)
    s_waitcnt vmcnt(10)
    v_mfma_f32_16x16x32_bf16 v[42:45], a[80:83], a[24:27], v[42:45]
    ds_read_b128 a[72:75], v12 offset:16384
    v_mfma_f32_16x16x32_bf16 v[70:73], a[80:83], a[28:31], v[70:73]
    buffer_load_dwordx4 v[240:243], v1, s[16:19], s40 offen offset:1024 sc1
    v_mfma_f32_16x16x32_bf16 v[46:49], a[84:87], a[24:27], v[46:49]
    ds_read_b128 a[76:79], v12 offset:17408
    v_mfma_f32_16x16x32_bf16 v[74:77], a[84:87], a[28:31], v[74:77]
    v_mfma_f32_16x16x32_bf16 v[50:53], a[88:91], a[48:51], v[50:53]
    ds_read_b128 a[80:83], v12 offset:23552
    v_mfma_f32_16x16x32_bf16 v[78:81], a[88:91], a[52:55], v[78:81]
    buffer_load_dwordx4 v[244:247], v1, s[16:19], s40 offen offset:2048 sc1
    s_waitcnt lgkmcnt(3)
    v_mfma_f32_16x16x32_bf16 v[54:57], a[92:95], a[48:51], v[54:57]
    ds_read_b128 a[84:87], v12 offset:24576
    v_mfma_f32_16x16x32_bf16 v[82:85], a[92:95], a[52:55], v[82:85]
    v_mfma_f32_16x16x32_bf16 v[50:53], a[64:67], a[56:59], v[50:53]
    ds_read_b128 a[88:91], v12 offset:30720
    v_fmac_f32 v98, v34, v42
    v_fmac_f32 v99, v34, v43
    v_fmac_f32 v100, v34, v44
    v_mfma_f32_16x16x32_bf16 v[78:81], a[64:67], a[60:63], v[78:81]
    buffer_load_dwordx4 v[248:251], v1, s[16:19], s40 offen offset:3072 sc1
    s_add_u32 s40, s40, 4096
    v_fmac_f32 v101, v34, v45
    v_max_f32 v42, 0, v98
    v_mfma_f32_16x16x32_bf16 v[54:57], a[68:71], a[56:59], v[54:57]
    ds_read_b128 a[92:95], v12 offset:31744
    v_max_f32 v43, 0, v99
    v_max_f32 v44, 0, v100
    v_max_f32 v45, 0, v101
    v_mfma_f32_16x16x32_bf16 v[82:85], a[68:71], a[60:63], v[82:85]
    s_waitcnt lgkmcnt(3)
    v_mul_f32 v42, v42, v42
    v_mul_f32 v43, v43, v43
    v_mul_f32 v44, v44, v44
    v_mfma_f32_16x16x32_bf16 v[50:53], a[72:75], a[0:3], v[50:53]
    ds_read_b128 a[64:67], v12 offset:37888
    v_mul_f32 v45, v45, v45
    v_fmac_f32 v102, v34, v46
    v_fmac_f32 v103, v34, v47
    v_mfma_f32_16x16x32_bf16 v[78:81], a[72:75], a[4:7], v[78:81]
    buffer_load_dwordx4 v[252:255], v1, s[16:19], s40 offen offset:0 sc1
    v_fmac_f32 v104, v34, v48
    v_fmac_f32 v105, v34, v49
    v_max_f32 v46, 0, v102
    v_mfma_f32_16x16x32_bf16 v[54:57], a[76:79], a[0:3], v[54:57]
    ds_read_b128 a[68:71], v12 offset:38912
    v_max_f32 v47, 0, v103
    v_max_f32 v48, 0, v104
    v_max_f32 v49, 0, v105
    v_mfma_f32_16x16x32_bf16 v[82:85], a[76:79], a[4:7], v[82:85]
    v_mul_f32 v46, v46, v46
    v_mul_f32 v47, v47, v47
    v_mul_f32 v48, v48, v48
    v_mul_f32 v49, v49, v49
    v_mfma_f32_16x16x32_bf16 v[50:53], a[80:83], a[8:11], v[50:53]
    ds_read_b128 a[72:75], v12 offset:4096
    v_cvt_pk_bf16_f32 v98, v42, v43
    v_cvt_pk_bf16_f32 v99, v44, v45
    v_cvt_pk_bf16_f32 v100, v46, v47
    v_mfma_f32_16x16x32_bf16 v[78:81], a[80:83], a[12:15], v[78:81]
    s_waitcnt lgkmcnt(3)
    v_cvt_pk_bf16_f32 v101, v48, v49
    buffer_store_dwordx4 v[98:101], v1, s[16:19], s27 offen offset:0 sc1
    v_fmac_f32 v128, v38, v70
    v_mfma_f32_16x16x32_bf16 v[54:57], a[84:87], a[8:11], v[54:57]
    ds_read_b128 a[76:79], v12 offset:5120
    v_fmac_f32 v129, v38, v71
    v_fmac_f32 v130, v38, v72
    v_fmac_f32 v131, v38, v73
    v_mfma_f32_16x16x32_bf16 v[82:85], a[84:87], a[12:15], v[82:85]
    v_max_f32 v70, 0, v128
    v_max_f32 v71, 0, v129
    v_max_f32 v72, 0, v130
    v_max_f32 v73, 0, v131
    v_mfma_f32_16x16x32_bf16 v[50:53], a[88:91], a[16:19], v[50:53]
    ds_read_b128 a[80:83], v12 offset:11264
    v_mul_f32 v70, v70, v70
    v_mul_f32 v71, v71, v71
    v_mul_f32 v72, v72, v72
    v_mfma_f32_16x16x32_bf16 v[78:81], a[88:91], a[20:23], v[78:81]
    v_mul_f32 v73, v73, v73
    v_fmac_f32 v132, v38, v74
    v_fmac_f32 v133, v38, v75
    v_fmac_f32 v134, v38, v76
    v_mfma_f32_16x16x32_bf16 v[54:57], a[92:95], a[16:19], v[54:57]
    ds_read_b128 a[84:87], v12 offset:12288
    v_fmac_f32 v135, v38, v77
    v_max_f32 v74, 0, v132
    v_max_f32 v75, 0, v133
    v_mfma_f32_16x16x32_bf16 v[82:85], a[92:95], a[20:23], v[82:85]
    s_waitcnt lgkmcnt(3)
    v_max_f32 v76, 0, v134
    v_max_f32 v77, 0, v135
    v_mul_f32 v74, v74, v74
    v_mfma_f32_16x16x32_bf16 v[50:53], a[64:67], a[24:27], v[50:53]
    ds_read_b128 a[88:91], v12 offset:18432
    v_mul_f32 v75, v75, v75
    v_mul_f32 v76, v76, v76
    v_mul_f32 v77, v77, v77
    v_mfma_f32_16x16x32_bf16 v[78:81], a[64:67], a[28:31], v[78:81]
    v_cvt_pk_bf16_f32 v128, v70, v71
    v_cvt_pk_bf16_f32 v129, v72, v73
    v_cvt_pk_bf16_f32 v130, v74, v75
    v_cvt_pk_bf16_f32 v131, v76, v77
    v_mfma_f32_16x16x32_bf16 v[54:57], a[68:71], a[24:27], v[54:57]
    ds_read_b128 a[92:95], v12 offset:19456
    buffer_store_dwordx4 v[128:131], v20, s[16:19], s27 offen offset:0 sc1
    v_mfma_f32_16x16x32_bf16 v[82:85], a[68:71], a[28:31], v[82:85]
    v_mfma_f32_16x16x32_bf16 v[58:61], a[72:75], a[48:51], v[58:61]
    ds_read_b128 a[64:67], v12 offset:25600
    v_mfma_f32_16x16x32_bf16 v[86:89], a[72:75], a[52:55], v[86:89]
    s_waitcnt lgkmcnt(3)
    v_mfma_f32_16x16x32_bf16 v[62:65], a[76:79], a[48:51], v[62:65]
    ds_read_b128 a[68:71], v12 offset:26624
    v_mfma_f32_16x16x32_bf16 v[90:93], a[76:79], a[52:55], v[90:93]
    v_mfma_f32_16x16x32_bf16 v[58:61], a[80:83], a[56:59], v[58:61]
    ds_read_b128 a[72:75], v12 offset:32768
    v_fmac_f32 v106, v34, v50
    v_fmac_f32 v107, v34, v51
    v_fmac_f32 v108, v34, v52
    v_mfma_f32_16x16x32_bf16 v[86:89], a[80:83], a[60:63], v[86:89]
    v_fmac_f32 v109, v34, v53
    v_max_f32 v50, 0, v106
    v_max_f32 v51, 0, v107
    v_max_f32 v52, 0, v108
    v_mfma_f32_16x16x32_bf16 v[62:65], a[84:87], a[56:59], v[62:65]
    ds_read_b128 a[76:79], v12 offset:33792
    v_max_f32 v53, 0, v109
    v_mul_f32 v50, v50, v50
    v_mul_f32 v51, v51, v51
    v_mfma_f32_16x16x32_bf16 v[90:93], a[84:87], a[60:63], v[90:93]
    s_waitcnt lgkmcnt(3)
    v_mul_f32 v52, v52, v52
    v_mul_f32 v53, v53, v53
    v_fmac_f32 v110, v34, v54
    v_mfma_f32_16x16x32_bf16 v[58:61], a[88:91], a[0:3], v[58:61]
    ds_read_b128 a[80:83], v12 offset:39936
    v_fmac_f32 v111, v34, v55
    v_fmac_f32 v112, v34, v56
    v_fmac_f32 v113, v34, v57
    v_mfma_f32_16x16x32_bf16 v[86:89], a[88:91], a[4:7], v[86:89]
    v_max_f32 v54, 0, v110
    v_max_f32 v55, 0, v111
    v_max_f32 v56, 0, v112
    v_max_f32 v57, 0, v113
    v_mfma_f32_16x16x32_bf16 v[62:65], a[92:95], a[0:3], v[62:65]
    ds_read_b128 a[84:87], v12 offset:40960
    v_mul_f32 v54, v54, v54
    v_mul_f32 v55, v55, v55
    v_mul_f32 v56, v56, v56
    v_mfma_f32_16x16x32_bf16 v[90:93], a[92:95], a[4:7], v[90:93]
    v_mul_f32 v57, v57, v57
    v_cvt_pk_bf16_f32 v106, v50, v51
    v_cvt_pk_bf16_f32 v107, v52, v53
    v_cvt_pk_bf16_f32 v108, v54, v55
    v_mfma_f32_16x16x32_bf16 v[58:61], a[64:67], a[8:11], v[58:61]
    ds_read_b128 a[88:91], v12 offset:6144
    v_cvt_pk_bf16_f32 v109, v56, v57
    buffer_store_dwordx4 v[106:109], v1, s[16:19], s27 offen offset:1024 sc1
    v_fmac_f32 v136, v38, v78
    v_mfma_f32_16x16x32_bf16 v[86:89], a[64:67], a[12:15], v[86:89]
    s_waitcnt lgkmcnt(3)
    v_fmac_f32 v137, v38, v79
    v_fmac_f32 v138, v38, v80
    v_fmac_f32 v139, v38, v81
    v_mfma_f32_16x16x32_bf16 v[62:65], a[68:71], a[8:11], v[62:65]
    ds_read_b128 a[92:95], v12 offset:13312
    v_max_f32 v78, 0, v136
    v_max_f32 v79, 0, v137
    v_max_f32 v80, 0, v138
    v_mfma_f32_16x16x32_bf16 v[90:93], a[68:71], a[12:15], v[90:93]
    v_max_f32 v81, 0, v139
    v_mul_f32 v78, v78, v78
    v_mul_f32 v79, v79, v79
    v_mul_f32 v80, v80, v80
    v_mfma_f32_16x16x32_bf16 v[58:61], a[72:75], a[16:19], v[58:61]
    ds_read_b128 a[64:67], v12 offset:20480
    v_mul_f32 v81, v81, v81
    v_fmac_f32 v140, v38, v82
    v_fmac_f32 v141, v38, v83
    v_mfma_f32_16x16x32_bf16 v[86:89], a[72:75], a[20:23], v[86:89]
    v_fmac_f32 v142, v38, v84
    v_fmac_f32 v143, v38, v85
    v_max_f32 v82, 0, v140
    v_max_f32 v83, 0, v141
    v_mfma_f32_16x16x32_bf16 v[62:65], a[76:79], a[16:19], v[62:65]
    ds_read_b128 a[68:71], v12 offset:27648
    v_max_f32 v84, 0, v142
    v_max_f32 v85, 0, v143
    v_mul_f32 v82, v82, v82
    v_mfma_f32_16x16x32_bf16 v[90:93], a[76:79], a[20:23], v[90:93]
    s_waitcnt lgkmcnt(3)
    v_mul_f32 v83, v83, v83
    v_mul_f32 v84, v84, v84
    v_mul_f32 v85, v85, v85
    v_mfma_f32_16x16x32_bf16 v[58:61], a[80:83], a[24:27], v[58:61]
    ds_read_b128 a[72:75], v12 offset:34816
    v_cvt_pk_bf16_f32 v136, v78, v79
    v_cvt_pk_bf16_f32 v137, v80, v81
    v_cvt_pk_bf16_f32 v138, v82, v83
    v_mfma_f32_16x16x32_bf16 v[86:89], a[80:83], a[28:31], v[86:89]
    v_cvt_pk_bf16_f32 v139, v84, v85
    buffer_store_dwordx4 v[136:139], v20, s[16:19], s27 offen offset:1024 sc1
    v_mfma_f32_16x16x32_bf16 v[62:65], a[84:87], a[24:27], v[62:65]
    ds_read_b128 a[76:79], v12 offset:41984
    v_mfma_f32_16x16x32_bf16 v[90:93], a[84:87], a[28:31], v[90:93]
    v_mfma_f32_16x16x32_bf16 v[66:69], a[88:91], a[48:51], v[66:69]
    v_mfma_f32_16x16x32_bf16 v[94:97], a[88:91], a[52:55], v[94:97]
    s_waitcnt lgkmcnt(2)
    v_mfma_f32_16x16x32_bf16 v[66:69], a[92:95], a[56:59], v[66:69]
    v_mfma_f32_16x16x32_bf16 v[94:97], a[92:95], a[60:63], v[94:97]
    v_mfma_f32_16x16x32_bf16 v[66:69], a[64:67], a[0:3], v[66:69]
    v_fmac_f32 v114, v34, v58
    v_fmac_f32 v115, v34, v59
    v_fmac_f32 v116, v34, v60
    v_fmac_f32 v117, v34, v61
    v_mfma_f32_16x16x32_bf16 v[94:97], a[64:67], a[4:7], v[94:97]
    v_max_f32 v58, 0, v114
    v_max_f32 v59, 0, v115
    v_max_f32 v60, 0, v116
    v_max_f32 v61, 0, v117
    v_mfma_f32_16x16x32_bf16 v[66:69], a[68:71], a[8:11], v[66:69]
    v_mul_f32 v58, v58, v58
    v_mul_f32 v59, v59, v59
    v_mul_f32 v60, v60, v60
    v_mul_f32 v61, v61, v61
    v_mfma_f32_16x16x32_bf16 v[94:97], a[68:71], a[12:15], v[94:97]
    s_waitcnt lgkmcnt(0)
    v_fmac_f32 v118, v34, v62
    v_fmac_f32 v119, v34, v63
    v_fmac_f32 v120, v34, v64
    v_mfma_f32_16x16x32_bf16 v[66:69], a[72:75], a[16:19], v[66:69]
    v_fmac_f32 v121, v34, v65
    v_max_f32 v62, 0, v118
    v_max_f32 v63, 0, v119
    v_max_f32 v64, 0, v120
    v_mfma_f32_16x16x32_bf16 v[94:97], a[72:75], a[20:23], v[94:97]
    v_max_f32 v65, 0, v121
    v_mul_f32 v62, v62, v62
    v_mul_f32 v63, v63, v63
    v_mul_f32 v64, v64, v64
    v_mfma_f32_16x16x32_bf16 v[66:69], a[76:79], a[24:27], v[66:69]
    v_mul_f32 v65, v65, v65
    v_cvt_pk_bf16_f32 v114, v58, v59
    v_cvt_pk_bf16_f32 v115, v60, v61
    v_cvt_pk_bf16_f32 v116, v62, v63
    v_mfma_f32_16x16x32_bf16 v[94:97], a[76:79], a[28:31], v[94:97]
    v_cvt_pk_bf16_f32 v117, v64, v65
    buffer_store_dwordx4 v[114:117], v1, s[16:19], s46 offen offset:0 sc1
    v_fmac_f32 v144, v38, v86
    v_fmac_f32 v145, v38, v87
    s_waitcnt vmcnt(1)
    v_mov_b32 v8, 6
    s_barrier
    buffer_store_dword v8, v2, s[16:19], s95 offen
    buffer_store_dword v8, v2, s[16:19], s15 offen sc1
    v_fmac_f32 v146, v38, v88
    v_fmac_f32 v147, v38, v89
    v_max_f32 v86, 0, v144
    v_max_f32 v87, 0, v145
    v_max_f32 v88, 0, v146
    v_max_f32 v89, 0, v147
    v_mul_f32 v86, v86, v86
    v_mul_f32 v87, v87, v87
    v_mul_f32 v88, v88, v88
    v_mul_f32 v89, v89, v89
    v_fmac_f32 v148, v38, v90
    v_fmac_f32 v149, v38, v91
    v_fmac_f32 v150, v38, v92
    v_fmac_f32 v151, v38, v93
    v_max_f32 v90, 0, v148
    v_max_f32 v91, 0, v149
    v_max_f32 v92, 0, v150
    v_max_f32 v93, 0, v151
    v_mul_f32 v90, v90, v90
    v_mul_f32 v91, v91, v91
    v_mul_f32 v92, v92, v92
    v_mul_f32 v93, v93, v93
    v_cvt_pk_bf16_f32 v144, v86, v87
    v_cvt_pk_bf16_f32 v145, v88, v89
    v_cvt_pk_bf16_f32 v146, v90, v91
    v_cvt_pk_bf16_f32 v147, v92, v93
    buffer_store_dwordx4 v[144:147], v20, s[16:19], s46 offen offset:0 sc1
    v_pk_fma_f32 v[66:67], v[66:67], v[34:35], v[122:123] op_sel_hi:[1,0,1]
    v_pk_fma_f32 v[68:69], v[68:69], v[34:35], v[124:125] op_sel_hi:[1,0,1]
    v_max_f32 v66, 0, v66
    v_max_f32 v67, 0, v67
    v_max_f32 v68, 0, v68
    v_max_f32 v69, 0, v69
    v_pk_mul_f32 v[66:67], v[66:67], v[66:67]
    v_pk_mul_f32 v[68:69], v[68:69], v[68:69]
    v_cvt_pk_bf16_f32 v44, v66, v67
    v_cvt_pk_bf16_f32 v45, v68, v69
    v_pk_fma_f32 v[94:95], v[94:95], v[38:39], v[152:153] op_sel_hi:[1,0,1]
    v_pk_fma_f32 v[96:97], v[96:97], v[38:39], v[154:155] op_sel_hi:[1,0,1]
    v_max_f32 v94, 0, v94
    v_max_f32 v95, 0, v95
    v_max_f32 v96, 0, v96
    v_max_f32 v97, 0, v97
    v_pk_mul_f32 v[94:95], v[94:95], v[94:95]
    v_pk_mul_f32 v[96:97], v[96:97], v[96:97]
    v_cvt_pk_bf16_f32 v46, v94, v95
    v_cvt_pk_bf16_f32 v47, v96, v97
    s_nop 0
    v_permlane16_swap_b32 v44, v46
    v_permlane16_swap_b32 v45, v47
    buffer_store_dwordx4 v[44:47], v4, s[16:19], s47 offen sc1
    v_lshrrev_b32 v5, 5, v0
    v_mul_u32_u24 v5, 80, v5
    v_add_u32 v5, 147712, v5
    v_bfe_u32 v6, v0, 4, 1
    v_mul_u32_u24 v7, 48, v6
    v_add_u32 v7, v5, v7
    v_lshl_add_u32 v5, v6, 3, v5
    ds_read_b128 v[116:119], v7
    ds_read_b128 v[120:123], v7 offset:16
    ds_read_b64 v[124:125], v5 offset:32
    s_and_b32 s30, s59, 7
    s_mul_i32 s30, s30, 131072
    s_mul_i32 s29, s57, 32768
    s_add_u32 s30, s30, s29
    s_add_u32 s30, s30, s92
    s_add_u32 s28, s3, 1
    s_and_b32 s28, s28, 3
    s_mul_i32 s29, s28, 15360
    s_add_u32 s29, s29, 0
    v_add_u32 v20, s29, v1
    s_mul_i32 s28, s28, 131072
    s_add_u32 s24, s28, s30
    s_add_u32 s28, s3, 2
    s_and_b32 s28, s28, 3
    s_mul_i32 s29, s28, 15360
    s_add_u32 s29, s29, 5120
    v_add_u32 v21, s29, v1
    s_mul_i32 s28, s28, 131072
    s_add_u32 s25, s28, s30
    s_add_u32 s28, s3, 3
    s_and_b32 s28, s28, 3
    s_mul_i32 s29, s28, 15360
    s_add_u32 s29, s29, 10240
    v_add_u32 v22, s29, v1
    s_mul_i32 s28, s28, 131072
    s_add_u32 s26, s28, s30
    s_add_u32 s28, s3, 4
    s_and_b32 s28, s28, 3
    s_mul_i32 s29, s28, 15360
    s_add_u32 s29, s29, 0
    v_add_u32 v23, s29, v1
    s_mul_i32 s28, s28, 131072
    s_add_u32 s27, s28, s30
    buffer_load_dword v34, v9, s[16:19], s95 offen sc1
    v_lshlrev_b32 v136, 16, v24
    v_and_b32 v137, 0xffff0000, v24
    v_lshlrev_b32 v138, 16, v25
    v_and_b32 v139, 0xffff0000, v25
    v_lshlrev_b32 v140, 16, v26
    v_and_b32 v141, 0xffff0000, v26
    v_lshlrev_b32 v142, 16, v27
    v_and_b32 v143, 0xffff0000, v27
    v_lshlrev_b32 v144, 16, v28
    v_and_b32 v145, 0xffff0000, v28
    v_lshlrev_b32 v146, 16, v29
    v_and_b32 v147, 0xffff0000, v29
    v_lshlrev_b32 v148, 16, v30
    v_and_b32 v149, 0xffff0000, v30
    v_lshlrev_b32 v150, 16, v31
    v_and_b32 v151, 0xffff0000, v31
    v_lshlrev_b32 v152, 16, v32
    v_and_b32 v153, 0xffff0000, v32
    v_lshlrev_b32 v154, 16, v33
    v_and_b32 v155, 0xffff0000, v33
    s_waitcnt lgkmcnt(2)
    v_lshlrev_b32 v96, 16, v116
    v_and_b32 v97, 0xffff0000, v116
    v_lshlrev_b32 v98, 16, v117
    v_and_b32 v99, 0xffff0000, v117
    v_lshlrev_b32 v100, 16, v118
    v_and_b32 v101, 0xffff0000, v118
    v_lshlrev_b32 v102, 16, v119
    v_and_b32 v103, 0xffff0000, v119
    s_waitcnt lgkmcnt(1)
    v_lshlrev_b32 v104, 16, v120
    v_and_b32 v105, 0xffff0000, v120
    v_lshlrev_b32 v106, 16, v121
    v_and_b32 v107, 0xffff0000, v121
    v_lshlrev_b32 v108, 16, v122
    v_and_b32 v109, 0xffff0000, v122
    v_lshlrev_b32 v110, 16, v123
    v_and_b32 v111, 0xffff0000, v123
    s_waitcnt lgkmcnt(0)
    v_lshlrev_b32 v112, 16, v124
    v_and_b32 v113, 0xffff0000, v124
    v_lshlrev_b32 v114, 16, v125
    v_and_b32 v115, 0xffff0000, v125
    v_pk_add_f32 v[136:137], v[136:137], v[96:97]
    v_pk_add_f32 v[138:139], v[138:139], v[98:99]
    v_pk_add_f32 v[140:141], v[140:141], v[100:101]
    v_pk_add_f32 v[142:143], v[142:143], v[102:103]
    v_pk_add_f32 v[144:145], v[144:145], v[104:105]
    v_pk_add_f32 v[146:147], v[146:147], v[106:107]
    v_pk_add_f32 v[148:149], v[148:149], v[108:109]
    v_pk_add_f32 v[150:151], v[150:151], v[110:111]
    v_pk_add_f32 v[152:153], v[152:153], v[112:113]
    v_pk_add_f32 v[154:155], v[154:155], v[114:115]
    s_waitcnt vmcnt(1)
    v_mov_b32 v8, 7
    s_cmp_lg_u32 s3, 0
    s_cbranch_scc1 L_polled_25
    s_waitcnt vmcnt(0)
    v_cmp_gt_u32 s[0:1], 6, v34
    s_mov_b32 s94, 0
    s_cmp_eq_u64 s[0:1], 0
    s_cbranch_scc1 L_polled_25
L_poll_24:
    s_add_u32 s94, s94, 1
    s_and_b32 s0, s94, 7
    s_cselect_b32 s0, s95, s15
    buffer_load_dword v34, v9, s[16:19], s0 offen sc1
    s_cmp_gt_u32 s94, 0x40000
    s_cbranch_scc1 L_polled_25
    s_waitcnt vmcnt(0)
    v_cmp_gt_u32 s[0:1], 6, v34
    s_nop 0
    s_cmp_eq_u64 s[0:1], 0
    s_cbranch_scc0 L_poll_24
L_polled_25:
    s_barrier
    buffer_store_dword v8, v2, s[16:19], s95 offen
    buffer_store_dword v8, v2, s[16:19], s15 offen sc1
    buffer_load_dwordx4 a[0:3], v16, s[16:19], s24 offen offset:0 sc1
    s_nop 0
    buffer_load_dwordx4 a[4:7], v16, s[16:19], s24 offen offset:1024 sc1
    s_nop 0
    buffer_load_dwordx4 a[8:11], v16, s[16:19], s24 offen offset:2048 sc1
    s_nop 0
    buffer_load_dwordx4 a[12:15], v16, s[16:19], s24 offen offset:3072 sc1
    s_nop 0
    buffer_load_dwordx4 a[16:19], v17, s[16:19], s24 offen offset:0 sc1
    s_nop 0
    buffer_load_dwordx4 a[20:23], v17, s[16:19], s24 offen offset:1024 sc1
    s_nop 0
    buffer_load_dwordx4 a[24:27], v17, s[16:19], s24 offen offset:2048 sc1
    s_nop 0
    buffer_load_dwordx4 a[28:31], v17, s[16:19], s24 offen offset:3072 sc1
    s_nop 0
    s_mov_b32 s20, s50
    s_mov_b32 s21, s51
    s_mov_b32 s22, 2621440
    s_mov_b32 s23, 0x20000
    s_lshl_b32 s28, s3, 12
    s_add_u32 s28, s28, 65536
    v_and_b32 v4, 15, v0
    v_mul_u32_u24 v4, 176, v4
    v_lshrrev_b32 v5, 5, v0
    v_mul_u32_u24 v5, 80, v5
    v_add3_u32 v4, v4, v5, s28
    v_bfe_u32 v6, v0, 4, 1
    v_mul_u32_u24 v7, 48, v6
    v_add_u32 v10, v4, v7
    v_lshl_add_u32 v11, v6, 3, v4
    v_add_u32 v11, 32, v11
    v_mul_u32_u24 v4, 6554, v0
    v_lshrrev_b32 v4, 16, v4
    v_mul_u32_u24 v5, 10, v4
    v_sub_u32 v5, v0, v5
    v_lshlrev_b32 v5, 4, v5
    v_mul_u32_u24 v6, 176, v4
    v_add3_u32 v12, v5, v6, s28
    s_movk_i32 s30, 7680
    s_movk_i32 s31, 15360
    s_waitcnt vmcnt(7)
    v_mfma_f32_16x16x32_bf16 v[36:39], a[96:99], a[0:3], 0
    buffer_load_dwordx4 a[32:35], v16, s[16:19], s25 offen offset:0 sc1
    v_mfma_f32_16x16x32_bf16 v[40:43], a[100:103], a[0:3], 0
    v_mfma_f32_16x16x32_bf16 v[44:47], a[104:107], a[0:3], 0
    buffer_load_dwordx4 a[64:67], v1, s[16:19], s40 offen offset:1024 sc1
    v_mfma_f32_16x16x32_bf16 v[48:51], a[108:111], a[0:3], 0
    v_mfma_f32_16x16x32_bf16 v[52:55], a[112:115], a[0:3], 0
    s_waitcnt vmcnt(8)
    v_mfma_f32_16x16x32_bf16 v[36:39], a[116:119], a[4:7], v[36:39]
    buffer_load_dwordx4 a[36:39], v16, s[16:19], s25 offen offset:1024 sc1
    v_mfma_f32_16x16x32_bf16 v[40:43], a[120:123], a[4:7], v[40:43]
    v_mfma_f32_16x16x32_bf16 v[44:47], a[124:127], a[4:7], v[44:47]
    v_mfma_f32_16x16x32_bf16 v[48:51], a[128:131], a[4:7], v[48:51]
    v_mfma_f32_16x16x32_bf16 v[52:55], a[132:135], a[4:7], v[52:55]
    s_waitcnt vmcnt(8)
    v_mfma_f32_16x16x32_bf16 v[36:39], a[136:139], a[8:11], v[36:39]
    buffer_load_dwordx4 a[40:43], v16, s[16:19], s25 offen offset:2048 sc1
    v_mfma_f32_16x16x32_bf16 v[40:43], a[140:143], a[8:11], v[40:43]
    v_mfma_f32_16x16x32_bf16 v[44:47], a[144:147], a[8:11], v[44:47]
    v_mfma_f32_16x16x32_bf16 v[48:51], a[148:151], a[8:11], v[48:51]
    v_mfma_f32_16x16x32_bf16 v[52:55], a[152:155], a[8:11], v[52:55]
    s_waitcnt vmcnt(8)
    v_mfma_f32_16x16x32_bf16 v[36:39], a[156:159], a[12:15], v[36:39]
    buffer_load_dwordx4 a[44:47], v16, s[16:19], s25 offen offset:3072 sc1
    v_mfma_f32_16x16x32_bf16 v[40:43], a[160:163], a[12:15], v[40:43]
    v_mfma_f32_16x16x32_bf16 v[44:47], a[164:167], a[12:15], v[44:47]
    buffer_load_dword v8, v9, s[16:19], s95 offen sc1
    v_mfma_f32_16x16x32_bf16 v[48:51], a[168:171], a[12:15], v[48:51]
    v_mfma_f32_16x16x32_bf16 v[52:55], a[172:175], a[12:15], v[52:55]
    s_waitcnt vmcnt(9)
    v_mfma_f32_16x16x32_bf16 v[36:39], a[176:179], a[16:19], v[36:39]
    buffer_load_dwordx4 a[48:51], v17, s[16:19], s25 offen offset:0 sc1
    v_mfma_f32_16x16x32_bf16 v[40:43], a[180:183], a[16:19], v[40:43]
    v_mfma_f32_16x16x32_bf16 v[44:47], a[184:187], a[16:19], v[44:47]
    v_mfma_f32_16x16x32_bf16 v[48:51], a[188:191], a[16:19], v[48:51]
    v_mfma_f32_16x16x32_bf16 v[52:55], a[192:195], a[16:19], v[52:55]
    s_waitcnt vmcnt(9)
    v_mfma_f32_16x16x32_bf16 v[36:39], a[196:199], a[20:23], v[36:39]
    buffer_load_dwordx4 a[52:55], v17, s[16:19], s25 offen offset:1024 sc1
    v_mfma_f32_16x16x32_bf16 v[40:43], a[200:203], a[20:23], v[40:43]
    v_mfma_f32_16x16x32_bf16 v[44:47], a[204:207], a[20:23], v[44:47]
    v_mfma_f32_16x16x32_bf16 v[48:51], a[208:211], a[20:23], v[48:51]
    v_mfma_f32_16x16x32_bf16 v[52:55], a[212:215], a[20:23], v[52:55]
    s_waitcnt vmcnt(9)
    v_mfma_f32_16x16x32_bf16 v[36:39], a[216:219], a[24:27], v[36:39]
    buffer_load_dwordx4 a[56:59], v17, s[16:19], s25 offen offset:2048 sc1
    v_mfma_f32_16x16x32_bf16 v[40:43], a[220:223], a[24:27], v[40:43]
    v_mfma_f32_16x16x32_bf16 v[44:47], a[224:227], a[24:27], v[44:47]
    buffer_load_dwordx4 a[68:71], v1, s[16:19], s40 offen offset:2048 sc1
    v_mfma_f32_16x16x32_bf16 v[48:51], a[228:231], a[24:27], v[48:51]
    v_mfma_f32_16x16x32_bf16 v[52:55], a[232:235], a[24:27], v[52:55]
    s_waitcnt vmcnt(10)
    v_mfma_f32_16x16x32_bf16 v[36:39], a[236:239], a[28:31], v[36:39]
    buffer_load_dwordx4 a[60:63], v17, s[16:19], s25 offen offset:3072 sc1
    v_mfma_f32_16x16x32_bf16 v[40:43], a[240:243], a[28:31], v[40:43]
    v_mfma_f32_16x16x32_bf16 v[44:47], a[244:247], a[28:31], v[44:47]
    v_mfma_f32_16x16x32_bf16 v[48:51], a[248:251], a[28:31], v[48:51]
    v_mfma_f32_16x16x32_bf16 v[52:55], a[252:255], a[28:31], v[52:55]
    s_waitcnt vmcnt(10)
    v_mfma_f32_16x16x32_bf16 v[56:59], a[96:99], a[32:35], 0
    buffer_load_dwordx4 a[0:3], v16, s[16:19], s26 offen offset:0 sc1
    v_mfma_f32_16x16x32_bf16 v[60:63], a[100:103], a[32:35], 0
    v_mfma_f32_16x16x32_bf16 v[64:67], a[104:107], a[32:35], 0
    v_mfma_f32_16x16x32_bf16 v[68:71], a[108:111], a[32:35], 0
    v_mfma_f32_16x16x32_bf16 v[72:75], a[112:115], a[32:35], 0
    s_waitcnt vmcnt(9)
    v_mfma_f32_16x16x32_bf16 v[56:59], a[116:119], a[36:39], v[56:59]
    buffer_load_dwordx4 a[4:7], v16, s[16:19], s26 offen offset:1024 sc1
    v_mfma_f32_16x16x32_bf16 v[60:63], a[120:123], a[36:39], v[60:63]
    v_mfma_f32_16x16x32_bf16 v[64:67], a[124:127], a[36:39], v[64:67]
    buffer_load_dwordx4 a[72:75], v1, s[16:19], s40 offen offset:3072 sc1
    s_add_u32 s40, s40, 4096
    v_mfma_f32_16x16x32_bf16 v[68:71], a[128:131], a[36:39], v[68:71]
    v_mfma_f32_16x16x32_bf16 v[72:75], a[132:135], a[36:39], v[72:75]
    s_waitcnt vmcnt(10)
    v_mfma_f32_16x16x32_bf16 v[56:59], a[136:139], a[40:43], v[56:59]
    buffer_load_dwordx4 a[8:11], v16, s[16:19], s26 offen offset:2048 sc1
    v_mfma_f32_16x16x32_bf16 v[60:63], a[140:143], a[40:43], v[60:63]
    v_mfma_f32_16x16x32_bf16 v[64:67], a[144:147], a[40:43], v[64:67]
    v_mfma_f32_16x16x32_bf16 v[68:71], a[148:151], a[40:43], v[68:71]
    v_mfma_f32_16x16x32_bf16 v[72:75], a[152:155], a[40:43], v[72:75]
    s_waitcnt vmcnt(10)
    v_mfma_f32_16x16x32_bf16 v[56:59], a[156:159], a[44:47], v[56:59]
    buffer_load_dwordx4 a[12:15], v16, s[16:19], s26 offen offset:3072 sc1
    v_mfma_f32_16x16x32_bf16 v[60:63], a[160:163], a[44:47], v[60:63]
    v_mfma_f32_16x16x32_bf16 v[64:67], a[164:167], a[44:47], v[64:67]
    v_mfma_f32_16x16x32_bf16 v[68:71], a[168:171], a[44:47], v[68:71]
    v_mfma_f32_16x16x32_bf16 v[72:75], a[172:175], a[44:47], v[72:75]
    s_cmp_lg_u32 s3, 0
    s_cbranch_scc1 L_polled_27
    s_waitcnt vmcnt(10)
    v_cmp_gt_u32 s[0:1], 7, v8
    s_mov_b32 s94, 0
    s_cmp_eq_u64 s[0:1], 0
    s_cbranch_scc1 L_polled_27
L_poll_26:
    s_add_u32 s94, s94, 1
    s_and_b32 s0, s94, 7
    s_cselect_b32 s0, s95, s15
    buffer_load_dword v8, v9, s[16:19], s0 offen sc1
    s_cmp_gt_u32 s94, 0x40000
    s_cbranch_scc1 L_polled_27
    s_waitcnt vmcnt(0)
    v_cmp_gt_u32 s[0:1], 7, v8
    s_nop 0
    s_cmp_eq_u64 s[0:1], 0
    s_cbranch_scc0 L_poll_26
L_polled_27:
    s_barrier
    s_waitcnt vmcnt(9)
    v_mfma_f32_16x16x32_bf16 v[56:59], a[176:179], a[48:51], v[56:59]
    buffer_load_dwordx4 a[16:19], v17, s[16:19], s26 offen offset:0 sc1
    v_mfma_f32_16x16x32_bf16 v[60:63], a[180:183], a[48:51], v[60:63]
    v_mfma_f32_16x16x32_bf16 v[64:67], a[184:187], a[48:51], v[64:67]
    buffer_load_dwordx4 a[76:79], v1, s[16:19], s40 offen offset:0 sc1
    v_mfma_f32_16x16x32_bf16 v[68:71], a[188:191], a[48:51], v[68:71]
    v_mfma_f32_16x16x32_bf16 v[72:75], a[192:195], a[48:51], v[72:75]
    s_waitcnt vmcnt(10)
    v_mfma_f32_16x16x32_bf16 v[56:59], a[196:199], a[52:55], v[56:59]
    buffer_load_dwordx4 a[20:23], v17, s[16:19], s26 offen offset:1024 sc1
    v_mfma_f32_16x16x32_bf16 v[60:63], a[200:203], a[52:55], v[60:63]
    v_mfma_f32_16x16x32_bf16 v[64:67], a[204:207], a[52:55], v[64:67]
    v_mfma_f32_16x16x32_bf16 v[68:71], a[208:211], a[52:55], v[68:71]
    v_mfma_f32_16x16x32_bf16 v[72:75], a[212:215], a[52:55], v[72:75]
    s_waitcnt vmcnt(10)
    v_mfma_f32_16x16x32_bf16 v[56:59], a[216:219], a[56:59], v[56:59]
    buffer_load_dwordx4 a[24:27], v17, s[16:19], s26 offen offset:2048 sc1
    v_mfma_f32_16x16x32_bf16 v[60:63], a[220:223], a[56:59], v[60:63]
    v_mfma_f32_16x16x32_bf16 v[64:67], a[224:227], a[56:59], v[64:67]
    v_mfma_f32_16x16x32_bf16 v[68:71], a[228:231], a[56:59], v[68:71]
    v_mfma_f32_16x16x32_bf16 v[72:75], a[232:235], a[56:59], v[72:75]
    s_waitcnt vmcnt(9)
    v_mfma_f32_16x16x32_bf16 v[56:59], a[236:239], a[60:63], v[56:59]
    buffer_load_dwordx4 a[28:31], v17, s[16:19], s26 offen offset:3072 sc1
    v_mfma_f32_16x16x32_bf16 v[60:63], a[240:243], a[60:63], v[60:63]
    v_mfma_f32_16x16x32_bf16 v[64:67], a[244:247], a[60:63], v[64:67]
    buffer_load_dwordx4 a[80:83], v1, s[16:19], s40 offen offset:1024 sc1
    v_mfma_f32_16x16x32_bf16 v[68:71], a[248:251], a[60:63], v[68:71]
    v_mfma_f32_16x16x32_bf16 v[72:75], a[252:255], a[60:63], v[72:75]
    s_waitcnt vmcnt(10)
    v_mfma_f32_16x16x32_bf16 v[76:79], a[96:99], a[0:3], 0
    buffer_load_dwordx4 a[32:35], v18, s[16:19], s24 offen offset:0 sc1
    v_mfma_f32_16x16x32_bf16 v[80:83], a[100:103], a[0:3], 0
    v_mfma_f32_16x16x32_bf16 v[84:87], a[104:107], a[0:3], 0
    v_mfma_f32_16x16x32_bf16 v[88:91], a[108:111], a[0:3], 0
    v_mfma_f32_16x16x32_bf16 v[92:95], a[112:115], a[0:3], 0
    s_waitcnt vmcnt(10)
    v_mfma_f32_16x16x32_bf16 v[76:79], a[116:119], a[4:7], v[76:79]
    buffer_load_dwordx4 a[36:39], v18, s[16:19], s24 offen offset:1024 sc1
    v_mfma_f32_16x16x32_bf16 v[80:83], a[120:123], a[4:7], v[80:83]
    v_mfma_f32_16x16x32_bf16 v[84:87], a[124:127], a[4:7], v[84:87]
    v_mfma_f32_16x16x32_bf16 v[88:91], a[128:131], a[4:7], v[88:91]
    v_mfma_f32_16x16x32_bf16 v[92:95], a[132:135], a[4:7], v[92:95]
    s_waitcnt vmcnt(9)
    v_mfma_f32_16x16x32_bf16 v[76:79], a[136:139], a[8:11], v[76:79]
    buffer_load_dwordx4 a[40:43], v18, s[16:19], s24 offen offset:2048 sc1
    v_mfma_f32_16x16x32_bf16 v[80:83], a[140:143], a[8:11], v[80:83]
    v_mfma_f32_16x16x32_bf16 v[84:87], a[144:147], a[8:11], v[84:87]
    v_mfma_f32_16x16x32_bf16 v[88:91], a[148:151], a[8:11], v[88:91]
    v_mfma_f32_16x16x32_bf16 v[92:95], a[152:155], a[8:11], v[92:95]
    s_waitcnt vmcnt(9)
    v_mfma_f32_16x16x32_bf16 v[76:79], a[156:159], a[12:15], v[76:79]
    buffer_load_dwordx4 a[44:47], v18, s[16:19], s24 offen offset:3072 sc1
    v_mfma_f32_16x16x32_bf16 v[80:83], a[160:163], a[12:15], v[80:83]
    v_mfma_f32_16x16x32_bf16 v[84:87], a[164:167], a[12:15], v[84:87]
    v_mfma_f32_16x16x32_bf16 v[88:91], a[168:171], a[12:15], v[88:91]
    v_mfma_f32_16x16x32_bf16 v[92:95], a[172:175], a[12:15], v[92:95]
    s_waitcnt vmcnt(9)
    v_mfma_f32_16x16x32_bf16 v[76:79], a[176:179], a[16:19], v[76:79]
    buffer_load_dwordx4 a[48:51], v19, s[16:19], s24 offen offset:0 sc1
    v_mfma_f32_16x16x32_bf16 v[80:83], a[180:183], a[16:19], v[80:83]
    v_mfma_f32_16x16x32_bf16 v[84:87], a[184:187], a[16:19], v[84:87]
    v_mfma_f32_16x16x32_bf16 v[88:91], a[188:191], a[16:19], v[88:91]
    v_mfma_f32_16x16x32_bf16 v[92:95], a[192:195], a[16:19], v[92:95]
    s_waitcnt vmcnt(8)
    v_mfma_f32_16x16x32_bf16 v[76:79], a[196:199], a[20:23], v[76:79]
    buffer_load_dwordx4 a[52:55], v19, s[16:19], s24 offen offset:1024 sc1
    v_mfma_f32_16x16x32_bf16 v[80:83], a[200:203], a[20:23], v[80:83]
    v_mfma_f32_16x16x32_bf16 v[84:87], a[204:207], a[20:23], v[84:87]
    v_mfma_f32_16x16x32_bf16 v[88:91], a[208:211], a[20:23], v[88:91]
    v_mfma_f32_16x16x32_bf16 v[92:95], a[212:215], a[20:23], v[92:95]
    s_waitcnt vmcnt(8)
    v_mfma_f32_16x16x32_bf16 v[76:79], a[216:219], a[24:27], v[76:79]
    buffer_load_dwordx4 a[56:59], v18, s[16:19], s25 offen offset:0 sc1
    v_mfma_f32_16x16x32_bf16 v[80:83], a[220:223], a[24:27], v[80:83]
    v_mfma_f32_16x16x32_bf16 v[84:87], a[224:227], a[24:27], v[84:87]
    v_mfma_f32_16x16x32_bf16 v[88:91], a[228:231], a[24:27], v[88:91]
    v_mfma_f32_16x16x32_bf16 v[92:95], a[232:235], a[24:27], v[92:95]
    s_waitcnt vmcnt(8)
    v_mfma_f32_16x16x32_bf16 v[76:79], a[236:239], a[28:31], v[76:79]
    buffer_load_dwordx4 a[60:63], v18, s[16:19], s25 offen offset:1024 sc1
    v_mfma_f32_16x16x32_bf16 v[80:83], a[240:243], a[28:31], v[80:83]
    v_mfma_f32_16x16x32_bf16 v[84:87], a[244:247], a[28:31], v[84:87]
    v_mfma_f32_16x16x32_bf16 v[88:91], a[248:251], a[28:31], v[88:91]
    v_mfma_f32_16x16x32_bf16 v[92:95], a[252:255], a[28:31], v[92:95]
    s_waitcnt vmcnt(7)
    v_mfma_f32_16x16x32_bf16 v[36:39], v[156:159], a[32:35], v[36:39]
    buffer_load_dwordx4 a[0:3], v18, s[16:19], s25 offen offset:2048 sc1
    v_mfma_f32_16x16x32_bf16 v[40:43], v[160:163], a[32:35], v[40:43]
    v_mfma_f32_16x16x32_bf16 v[44:47], v[164:167], a[32:35], v[44:47]
    v_mfma_f32_16x16x32_bf16 v[48:51], v[168:171], a[32:35], v[48:51]
    v_mfma_f32_16x16x32_bf16 v[52:55], v[172:175], a[32:35], v[52:55]
    s_waitcnt vmcnt(7)
    v_mfma_f32_16x16x32_bf16 v[36:39], v[176:179], a[36:39], v[36:39]
    buffer_load_dwordx4 a[4:7], v18, s[16:19], s25 offen offset:3072 sc1
    v_mfma_f32_16x16x32_bf16 v[40:43], v[180:183], a[36:39], v[40:43]
    v_mfma_f32_16x16x32_bf16 v[44:47], v[184:187], a[36:39], v[44:47]
    v_mfma_f32_16x16x32_bf16 v[48:51], v[188:191], a[36:39], v[48:51]
    v_mfma_f32_16x16x32_bf16 v[52:55], v[192:195], a[36:39], v[52:55]
    s_waitcnt vmcnt(7)
    v_mfma_f32_16x16x32_bf16 v[36:39], v[196:199], a[40:43], v[36:39]
    buffer_load_dwordx4 a[8:11], v19, s[16:19], s25 offen offset:0 sc1
    v_mfma_f32_16x16x32_bf16 v[40:43], v[200:203], a[40:43], v[40:43]
    v_mfma_f32_16x16x32_bf16 v[44:47], v[204:207], a[40:43], v[44:47]
    v_mfma_f32_16x16x32_bf16 v[48:51], v[208:211], a[40:43], v[48:51]
    v_mfma_f32_16x16x32_bf16 v[52:55], v[212:215], a[40:43], v[52:55]
    s_waitcnt vmcnt(7)
    v_mfma_f32_16x16x32_bf16 v[36:39], v[216:219], a[44:47], v[36:39]
    buffer_load_dwordx4 a[12:15], v19, s[16:19], s25 offen offset:1024 sc1
    v_mfma_f32_16x16x32_bf16 v[40:43], v[220:223], a[44:47], v[40:43]
    v_mfma_f32_16x16x32_bf16 v[44:47], v[224:227], a[44:47], v[44:47]
    v_mfma_f32_16x16x32_bf16 v[48:51], v[228:231], a[44:47], v[48:51]
    v_mfma_f32_16x16x32_bf16 v[52:55], v[232:235], a[44:47], v[52:55]
    s_waitcnt vmcnt(7)
    v_mfma_f32_16x16x32_bf16 v[36:39], v[236:239], a[48:51], v[36:39]
    buffer_load_dwordx4 a[16:19], v18, s[16:19], s26 offen offset:0 sc1
    v_mfma_f32_16x16x32_bf16 v[40:43], v[240:243], a[48:51], v[40:43]
    v_mfma_f32_16x16x32_bf16 v[44:47], v[244:247], a[48:51], v[44:47]
    v_mfma_f32_16x16x32_bf16 v[48:51], v[248:251], a[48:51], v[48:51]
    v_mfma_f32_16x16x32_bf16 v[52:55], v[252:255], a[48:51], v[52:55]
    s_waitcnt vmcnt(7)
    v_mfma_f32_16x16x32_bf16 v[36:39], a[64:67], a[52:55], v[36:39]
    buffer_load_dwordx4 a[20:23], v18, s[16:19], s26 offen offset:1024 sc1
    v_mfma_f32_16x16x32_bf16 v[40:43], a[68:71], a[52:55], v[40:43]
    v_mfma_f32_16x16x32_bf16 v[44:47], a[72:75], a[52:55], v[44:47]
    v_mfma_f32_16x16x32_bf16 v[48:51], a[76:79], a[52:55], v[48:51]
    v_mfma_f32_16x16x32_bf16 v[52:55], a[80:83], a[52:55], v[52:55]
    s_waitcnt vmcnt(7)
    v_mfma_f32_16x16x32_bf16 v[56:59], v[156:159], a[56:59], v[56:59]
    buffer_load_dwordx4 a[24:27], v18, s[16:19], s26 offen offset:2048 sc1
    v_mfma_f32_16x16x32_bf16 v[60:63], v[160:163], a[56:59], v[60:63]
    v_mfma_f32_16x16x32_bf16 v[64:67], v[164:167], a[56:59], v[64:67]
    v_mfma_f32_16x16x32_bf16 v[68:71], v[168:171], a[56:59], v[68:71]
    v_mfma_f32_16x16x32_bf16 v[72:75], v[172:175], a[56:59], v[72:75]
    ds_write_b128 v20, v[36:39] offset:0
    s_waitcnt vmcnt(7)
    v_mfma_f32_16x16x32_bf16 v[56:59], v[176:179], a[60:63], v[56:59]
    buffer_load_dwordx4 a[28:31], v18, s[16:19], s26 offen offset:3072 sc1
    v_mfma_f32_16x16x32_bf16 v[60:63], v[180:183], a[60:63], v[60:63]
    v_mfma_f32_16x16x32_bf16 v[64:67], v[184:187], a[60:63], v[64:67]
    v_mfma_f32_16x16x32_bf16 v[68:71], v[188:191], a[60:63], v[68:71]
    ds_write_b128 v20, v[40:43] offset:1024
    v_mfma_f32_16x16x32_bf16 v[72:75], v[192:195], a[60:63], v[72:75]
    s_waitcnt vmcnt(7)
    v_mfma_f32_16x16x32_bf16 v[56:59], v[196:199], a[0:3], v[56:59]
    buffer_load_dwordx4 a[32:35], v19, s[16:19], s26 offen offset:0 sc1
    v_mfma_f32_16x16x32_bf16 v[60:63], v[200:203], a[0:3], v[60:63]
    v_mfma_f32_16x16x32_bf16 v[64:67], v[204:207], a[0:3], v[64:67]
    ds_write_b128 v20, v[44:47] offset:2048
    v_mfma_f32_16x16x32_bf16 v[68:71], v[208:211], a[0:3], v[68:71]
    v_mfma_f32_16x16x32_bf16 v[72:75], v[212:215], a[0:3], v[72:75]
    s_waitcnt vmcnt(7)
    v_mfma_f32_16x16x32_bf16 v[56:59], v[216:219], a[4:7], v[56:59]
    buffer_load_dwordx4 a[36:39], v19, s[16:19], s26 offen offset:1024 sc1
    v_mfma_f32_16x16x32_bf16 v[60:63], v[220:223], a[4:7], v[60:63]
    ds_write_b128 v20, v[48:51] offset:3072
    v_mfma_f32_16x16x32_bf16 v[64:67], v[224:227], a[4:7], v[64:67]
    v_mfma_f32_16x16x32_bf16 v[68:71], v[228:231], a[4:7], v[68:71]
    v_mfma_f32_16x16x32_bf16 v[72:75], v[232:235], a[4:7], v[72:75]
    s_waitcnt vmcnt(7)
    v_mfma_f32_16x16x32_bf16 v[56:59], v[236:239], a[8:11], v[56:59]
    ds_write_b128 v20, v[52:55] offset:4096
    buffer_load_dwordx4 a[40:43], v16, s[16:19], s27 offen offset:0 sc1
    v_mfma_f32_16x16x32_bf16 v[60:63], v[240:243], a[8:11], v[60:63]
    v_mfma_f32_16x16x32_bf16 v[64:67], v[244:247], a[8:11], v[64:67]
    v_mfma_f32_16x16x32_bf16 v[68:71], v[248:251], a[8:11], v[68:71]
    v_mfma_f32_16x16x32_bf16 v[72:75], v[252:255], a[8:11], v[72:75]
    s_waitcnt vmcnt(7)
    v_mfma_f32_16x16x32_bf16 v[56:59], a[64:67], a[12:15], v[56:59]
    buffer_load_dwordx4 a[44:47], v16, s[16:19], s27 offen offset:1024 sc1
    v_mfma_f32_16x16x32_bf16 v[60:63], a[68:71], a[12:15], v[60:63]
    v_mfma_f32_16x16x32_bf16 v[64:67], a[72:75], a[12:15], v[64:67]
    v_mfma_f32_16x16x32_bf16 v[68:71], a[76:79], a[12:15], v[68:71]
    v_mfma_f32_16x16x32_bf16 v[72:75], a[80:83], a[12:15], v[72:75]
    s_waitcnt vmcnt(7)
    v_mfma_f32_16x16x32_bf16 v[76:79], v[156:159], a[16:19], v[76:79]
    buffer_load_dwordx4 a[48:51], v16, s[16:19], s27 offen offset:2048 sc1
    v_mfma_f32_16x16x32_bf16 v[80:83], v[160:163], a[16:19], v[80:83]
    v_mfma_f32_16x16x32_bf16 v[84:87], v[164:167], a[16:19], v[84:87]
    v_mfma_f32_16x16x32_bf16 v[88:91], v[168:171], a[16:19], v[88:91]
    v_mfma_f32_16x16x32_bf16 v[92:95], v[172:175], a[16:19], v[92:95]
    ds_write_b128 v21, v[56:59] offset:0
    s_waitcnt vmcnt(7)
    v_mfma_f32_16x16x32_bf16 v[76:79], v[176:179], a[20:23], v[76:79]
    buffer_load_dwordx4 a[52:55], v16, s[16:19], s27 offen offset:3072 sc1
    v_mfma_f32_16x16x32_bf16 v[80:83], v[180:183], a[20:23], v[80:83]
    v_mfma_f32_16x16x32_bf16 v[84:87], v[184:187], a[20:23], v[84:87]
    v_mfma_f32_16x16x32_bf16 v[88:91], v[188:191], a[20:23], v[88:91]
    ds_write_b128 v21, v[60:63] offset:1024
    v_mfma_f32_16x16x32_bf16 v[92:95], v[192:195], a[20:23], v[92:95]
    s_waitcnt vmcnt(7)
    v_mfma_f32_16x16x32_bf16 v[76:79], v[196:199], a[24:27], v[76:79]
    buffer_load_dwordx4 a[56:59], v17, s[16:19], s27 offen offset:0 sc1
    v_mfma_f32_16x16x32_bf16 v[80:83], v[200:203], a[24:27], v[80:83]
    v_mfma_f32_16x16x32_bf16 v[84:87], v[204:207], a[24:27], v[84:87]
    ds_write_b128 v21, v[64:67] offset:2048
    v_mfma_f32_16x16x32_bf16 v[88:91], v[208:211], a[24:27], v[88:91]
    v_mfma_f32_16x16x32_bf16 v[92:95], v[212:215], a[24:27], v[92:95]
    s_waitcnt vmcnt(7)
    v_mfma_f32_16x16x32_bf16 v[76:79], v[216:219], a[28:31], v[76:79]
    buffer_load_dwordx4 a[60:63], v17, s[16:19], s27 offen offset:1024 sc1
    v_mfma_f32_16x16x32_bf16 v[80:83], v[220:223], a[28:31], v[80:83]
    ds_write_b128 v21, v[68:71] offset:3072
    v_mfma_f32_16x16x32_bf16 v[84:87], v[224:227], a[28:31], v[84:87]
    v_mfma_f32_16x16x32_bf16 v[88:91], v[228:231], a[28:31], v[88:91]
    v_mfma_f32_16x16x32_bf16 v[92:95], v[232:235], a[28:31], v[92:95]
    s_waitcnt vmcnt(7)
    v_mfma_f32_16x16x32_bf16 v[76:79], v[236:239], a[32:35], v[76:79]
    ds_write_b128 v21, v[72:75] offset:4096
    buffer_load_dwordx4 a[0:3], v17, s[16:19], s27 offen offset:2048 sc1
    v_mfma_f32_16x16x32_bf16 v[80:83], v[240:243], a[32:35], v[80:83]
    v_mfma_f32_16x16x32_bf16 v[84:87], v[244:247], a[32:35], v[84:87]
    v_mfma_f32_16x16x32_bf16 v[88:91], v[248:251], a[32:35], v[88:91]
    v_mfma_f32_16x16x32_bf16 v[92:95], v[252:255], a[32:35], v[92:95]
    s_waitcnt vmcnt(7)
    v_mfma_f32_16x16x32_bf16 v[76:79], a[64:67], a[36:39], v[76:79]
    buffer_load_dwordx4 a[4:7], v17, s[16:19], s27 offen offset:3072 sc1
    v_mfma_f32_16x16x32_bf16 v[80:83], a[68:71], a[36:39], v[80:83]
    v_mfma_f32_16x16x32_bf16 v[84:87], a[72:75], a[36:39], v[84:87]
    v_mfma_f32_16x16x32_bf16 v[88:91], a[76:79], a[36:39], v[88:91]
    v_mfma_f32_16x16x32_bf16 v[92:95], a[80:83], a[36:39], v[92:95]
    s_waitcnt vmcnt(7)
    v_mfma_f32_16x16x32_bf16 v[96:99], a[96:99], a[40:43], v[136:139]
    buffer_load_dwordx4 a[8:11], v18, s[16:19], s27 offen offset:0 sc1
    v_mfma_f32_16x16x32_bf16 v[100:103], a[100:103], a[40:43], v[140:143]
    v_mfma_f32_16x16x32_bf16 v[104:107], a[104:107], a[40:43], v[144:147]
    v_mfma_f32_16x16x32_bf16 v[108:111], a[108:111], a[40:43], v[148:151]
    v_mfma_f32_16x16x32_bf16 v[112:115], a[112:115], a[40:43], v[152:155]
    ds_write_b128 v22, v[76:79] offset:0
    s_waitcnt vmcnt(7)
    v_mfma_f32_16x16x32_bf16 v[96:99], a[116:119], a[44:47], v[96:99]
    buffer_load_dwordx4 a[12:15], v18, s[16:19], s27 offen offset:1024 sc1
    v_mfma_f32_16x16x32_bf16 v[100:103], a[120:123], a[44:47], v[100:103]
    v_mfma_f32_16x16x32_bf16 v[104:107], a[124:127], a[44:47], v[104:107]
    v_mfma_f32_16x16x32_bf16 v[108:111], a[128:131], a[44:47], v[108:111]
    ds_write_b128 v22, v[80:83] offset:1024
    v_mfma_f32_16x16x32_bf16 v[112:115], a[132:135], a[44:47], v[112:115]
    s_waitcnt vmcnt(7)
    v_mfma_f32_16x16x32_bf16 v[96:99], a[136:139], a[48:51], v[96:99]
    buffer_load_dwordx4 a[16:19], v18, s[16:19], s27 offen offset:2048 sc1
    v_mfma_f32_16x16x32_bf16 v[100:103], a[140:143], a[48:51], v[100:103]
    v_mfma_f32_16x16x32_bf16 v[104:107], a[144:147], a[48:51], v[104:107]
    ds_write_b128 v22, v[84:87] offset:2048
    v_mfma_f32_16x16x32_bf16 v[108:111], a[148:151], a[48:51], v[108:111]
    v_mfma_f32_16x16x32_bf16 v[112:115], a[152:155], a[48:51], v[112:115]
    s_waitcnt vmcnt(7)
    v_mfma_f32_16x16x32_bf16 v[96:99], a[156:159], a[52:55], v[96:99]
    buffer_load_dwordx4 a[20:23], v18, s[16:19], s27 offen offset:3072 sc1
    v_mfma_f32_16x16x32_bf16 v[100:103], a[160:163], a[52:55], v[100:103]
    ds_write_b128 v22, v[88:91] offset:3072
    v_mfma_f32_16x16x32_bf16 v[104:107], a[164:167], a[52:55], v[104:107]
    v_mfma_f32_16x16x32_bf16 v[108:111], a[168:171], a[52:55], v[108:111]
    v_mfma_f32_16x16x32_bf16 v[112:115], a[172:175], a[52:55], v[112:115]
    s_waitcnt vmcnt(7)
    v_mfma_f32_16x16x32_bf16 v[96:99], a[176:179], a[56:59], v[96:99]
    ds_write_b128 v22, v[92:95] offset:4096
    buffer_load_dwordx4 a[24:27], v19, s[16:19], s27 offen offset:0 sc1
    v_mfma_f32_16x16x32_bf16 v[100:103], a[180:183], a[56:59], v[100:103]
    v_mfma_f32_16x16x32_bf16 v[104:107], a[184:187], a[56:59], v[104:107]
    v_mfma_f32_16x16x32_bf16 v[108:111], a[188:191], a[56:59], v[108:111]
    v_mfma_f32_16x16x32_bf16 v[112:115], a[192:195], a[56:59], v[112:115]
    s_waitcnt vmcnt(7)
    v_mfma_f32_16x16x32_bf16 v[96:99], a[196:199], a[60:63], v[96:99]
    s_waitcnt lgkmcnt(0)
    s_barrier
    ds_read_b128 v[76:79], v23 offset:10240
    buffer_load_dwordx4 a[28:31], v19, s[16:19], s27 offen offset:1024 sc1
    v_mfma_f32_16x16x32_bf16 v[100:103], a[200:203], a[60:63], v[100:103]
    ds_read_b128 v[80:83], v23 offset:11264
    v_mfma_f32_16x16x32_bf16 v[104:107], a[204:207], a[60:63], v[104:107]
    ds_read_b128 v[84:87], v23 offset:12288
    v_mfma_f32_16x16x32_bf16 v[108:111], a[208:211], a[60:63], v[108:111]
    ds_read_b128 v[88:91], v23 offset:13312
    v_mfma_f32_16x16x32_bf16 v[112:115], a[212:215], a[60:63], v[112:115]
    ds_read_b128 v[92:95], v23 offset:14336
    s_waitcnt vmcnt(7)
    v_mfma_f32_16x16x32_bf16 v[96:99], a[216:219], a[0:3], v[96:99]
    ds_read_b128 v[36:39], v23 offset:0
    v_mfma_f32_16x16x32_bf16 v[100:103], a[220:223], a[0:3], v[100:103]
    ds_read_b128 v[40:43], v23 offset:1024
    v_mfma_f32_16x16x32_bf16 v[104:107], a[224:227], a[0:3], v[104:107]
    ds_read_b128 v[44:47], v23 offset:2048
    v_mfma_f32_16x16x32_bf16 v[108:111], a[228:231], a[0:3], v[108:111]
    ds_read_b128 v[48:51], v23 offset:3072
    v_mfma_f32_16x16x32_bf16 v[112:115], a[232:235], a[0:3], v[112:115]
    ds_read_b128 v[52:55], v23 offset:4096
    s_waitcnt vmcnt(6)
    v_mfma_f32_16x16x32_bf16 v[96:99], a[236:239], a[4:7], v[96:99]
    ds_read_b128 v[56:59], v23 offset:5120
    v_mfma_f32_16x16x32_bf16 v[100:103], a[240:243], a[4:7], v[100:103]
    ds_read_b128 v[60:63], v23 offset:6144
    v_mfma_f32_16x16x32_bf16 v[104:107], a[244:247], a[4:7], v[104:107]
    ds_read_b128 v[64:67], v23 offset:7168
    v_mfma_f32_16x16x32_bf16 v[108:111], a[248:251], a[4:7], v[108:111]
    ds_read_b128 v[68:71], v23 offset:8192
    v_mfma_f32_16x16x32_bf16 v[112:115], a[252:255], a[4:7], v[112:115]
    ds_read_b128 v[72:75], v23 offset:9216
    s_waitcnt vmcnt(5)
    v_mfma_f32_16x16x32_bf16 v[96:99], v[156:159], a[8:11], v[96:99]
    v_mfma_f32_16x16x32_bf16 v[100:103], v[160:163], a[8:11], v[100:103]
    v_mfma_f32_16x16x32_bf16 v[104:107], v[164:167], a[8:11], v[104:107]
    v_mfma_f32_16x16x32_bf16 v[108:111], v[168:171], a[8:11], v[108:111]
    v_mfma_f32_16x16x32_bf16 v[112:115], v[172:175], a[8:11], v[112:115]
    s_waitcnt vmcnt(4)
    v_mfma_f32_16x16x32_bf16 v[96:99], v[176:179], a[12:15], v[96:99]
    s_waitcnt lgkmcnt(9)
    v_add_f32 v76, v76, v36
    v_add_f32 v77, v77, v37
    v_mfma_f32_16x16x32_bf16 v[100:103], v[180:183], a[12:15], v[100:103]
    v_add_f32 v78, v78, v38
    v_add_f32 v79, v79, v39
    v_mfma_f32_16x16x32_bf16 v[104:107], v[184:187], a[12:15], v[104:107]
    s_waitcnt lgkmcnt(8)
    v_add_f32 v80, v80, v40
    v_add_f32 v81, v81, v41
    v_mfma_f32_16x16x32_bf16 v[108:111], v[188:191], a[12:15], v[108:111]
    v_add_f32 v82, v82, v42
    v_add_f32 v83, v83, v43
    v_mfma_f32_16x16x32_bf16 v[112:115], v[192:195], a[12:15], v[112:115]
    s_waitcnt lgkmcnt(7)
    v_add_f32 v84, v84, v44
    v_add_f32 v85, v85, v45
    s_waitcnt vmcnt(3)
    v_mfma_f32_16x16x32_bf16 v[96:99], v[196:199], a[16:19], v[96:99]
    v_add_f32 v86, v86, v46
    v_add_f32 v87, v87, v47
    v_mfma_f32_16x16x32_bf16 v[100:103], v[200:203], a[16:19], v[100:103]
    s_waitcnt lgkmcnt(6)
    v_add_f32 v88, v88, v48
    v_add_f32 v89, v89, v49
    v_mfma_f32_16x16x32_bf16 v[104:107], v[204:207], a[16:19], v[104:107]
    v_add_f32 v90, v90, v50
    v_add_f32 v91, v91, v51
    v_mfma_f32_16x16x32_bf16 v[108:111], v[208:211], a[16:19], v[108:111]
    s_waitcnt lgkmcnt(5)
    v_add_f32 v92, v92, v52
    v_add_f32 v93, v93, v53
    v_mfma_f32_16x16x32_bf16 v[112:115], v[212:215], a[16:19], v[112:115]
    v_add_f32 v94, v94, v54
    v_add_f32 v95, v95, v55
    s_waitcnt vmcnt(2)
    v_mfma_f32_16x16x32_bf16 v[96:99], v[216:219], a[20:23], v[96:99]
    s_waitcnt lgkmcnt(4)
    v_add_f32 v76, v76, v56
    v_add_f32 v77, v77, v57
    v_mfma_f32_16x16x32_bf16 v[100:103], v[220:223], a[20:23], v[100:103]
    v_add_f32 v78, v78, v58
    v_add_f32 v79, v79, v59
    v_mfma_f32_16x16x32_bf16 v[104:107], v[224:227], a[20:23], v[104:107]
    s_waitcnt lgkmcnt(3)
    v_add_f32 v80, v80, v60
    v_add_f32 v81, v81, v61
    v_mfma_f32_16x16x32_bf16 v[108:111], v[228:231], a[20:23], v[108:111]
    v_add_f32 v82, v82, v62
    v_add_f32 v83, v83, v63
    v_mfma_f32_16x16x32_bf16 v[112:115], v[232:235], a[20:23], v[112:115]
    s_waitcnt lgkmcnt(2)
    v_add_f32 v84, v84, v64
    v_add_f32 v85, v85, v65
    s_waitcnt vmcnt(1)
    v_mfma_f32_16x16x32_bf16 v[96:99], v[236:239], a[24:27], v[96:99]
    v_add_f32 v86, v86, v66
    v_add_f32 v87, v87, v67
    v_mfma_f32_16x16x32_bf16 v[100:103], v[240:243], a[24:27], v[100:103]
    s_waitcnt lgkmcnt(1)
    v_add_f32 v88, v88, v68
    v_add_f32 v89, v89, v69
    v_mfma_f32_16x16x32_bf16 v[104:107], v[244:247], a[24:27], v[104:107]
    v_add_f32 v90, v90, v70
    v_add_f32 v91, v91, v71
    v_mfma_f32_16x16x32_bf16 v[108:111], v[248:251], a[24:27], v[108:111]
    s_waitcnt lgkmcnt(0)
    v_add_f32 v92, v92, v72
    v_add_f32 v93, v93, v73
    v_mfma_f32_16x16x32_bf16 v[112:115], v[252:255], a[24:27], v[112:115]
    v_add_f32 v94, v94, v74
    v_add_f32 v95, v95, v75
    s_waitcnt vmcnt(0)
    v_mfma_f32_16x16x32_bf16 v[96:99], a[64:67], a[28:31], v[96:99]
    v_mfma_f32_16x16x32_bf16 v[100:103], a[68:71], a[28:31], v[100:103]
    v_mfma_f32_16x16x32_bf16 v[104:107], a[72:75], a[28:31], v[104:107]
    v_mfma_f32_16x16x32_bf16 v[108:111], a[76:79], a[28:31], v[108:111]
    v_mfma_f32_16x16x32_bf16 v[112:115], a[80:83], a[28:31], v[112:115]
    s_nop 3
    v_pk_add_f32 v[76:77], v[76:77], v[96:97]
    v_pk_add_f32 v[78:79], v[78:79], v[98:99]
    v_pk_add_f32 v[80:81], v[80:81], v[100:101]
    v_pk_add_f32 v[82:83], v[82:83], v[102:103]
    v_pk_add_f32 v[84:85], v[84:85], v[104:105]
    v_pk_add_f32 v[86:87], v[86:87], v[106:107]
    v_pk_add_f32 v[88:89], v[88:89], v[108:109]
    v_pk_add_f32 v[90:91], v[90:91], v[110:111]
    v_pk_add_f32 v[92:93], v[92:93], v[112:113]
    v_pk_add_f32 v[94:95], v[94:95], v[114:115]
    v_cvt_pk_bf16_f32 v24, v76, v77
    v_cvt_pk_bf16_f32 v25, v78, v79
    v_cvt_pk_bf16_f32 v26, v80, v81
    v_cvt_pk_bf16_f32 v27, v82, v83
    ds_write_b128 v10, v[24:27]
    v_cvt_pk_bf16_f32 v28, v84, v85
    v_cvt_pk_bf16_f32 v29, v86, v87
    v_cvt_pk_bf16_f32 v30, v88, v89
    v_cvt_pk_bf16_f32 v31, v90, v91
    ds_write_b128 v10, v[28:31] offset:16
    v_cvt_pk_bf16_f32 v32, v92, v93
    v_cvt_pk_bf16_f32 v33, v94, v95
    ds_write_b64 v11, v[32:33]
    ds_read_b128 v[36:39], v12 offset:0
    ds_read_b128 v[40:43], v12 offset:1056
    ds_read_b128 v[44:47], v12 offset:2112
    s_waitcnt lgkmcnt(2)
    buffer_store_dwordx4 v[36:39], v14, s[20:23], 0 offen
    s_nop 0
    s_waitcnt lgkmcnt(1)
    buffer_store_dwordx4 v[40:43], v14, s[20:23], s30 offen
    s_nop 0
    s_waitcnt lgkmcnt(0)
    buffer_store_dwordx4 v[44:47], v15, s[20:23], s31 offen
    s_nop 0
L_end:
    s_endpgm
L_pol_10:
    s_mov_b32 s94, 0
L_pol_10_l:
    s_sleep 4
    buffer_load_dword v89, v88, s[24:27], 0 offen offset:128 sc1
    s_add_u32 s94, s94, 1
    s_waitcnt vmcnt(0)
    v_cmp_eq_u32 s[0:1], 0, v89
    s_cmp_gt_u32 s94, 0x40000
    s_cbranch_scc1 L_polok_11
    s_cmp_eq_u64 s[0:1], 0
    s_cbranch_scc0 L_pol_10_l
    s_branch L_polok_11
L_pkok_16_s:
    s_cmp_lg_u32 s3, 0
    s_cbranch_scc1 L_polled_29
    v_cmp_gt_u32 s[0:1], 2, v8
    s_mov_b32 s94, 0
    s_cmp_eq_u64 s[0:1], 0
    s_cbranch_scc1 L_polled_29
L_poll_28:
    s_add_u32 s94, s94, 1
    buffer_load_dword v8, v37, s[16:19], s15 offen sc1
    s_cmp_gt_u32 s94, 0x40000
    s_cbranch_scc1 L_polled_29
    s_waitcnt vmcnt(0)
    v_cmp_gt_u32 s[0:1], 2, v8
    s_nop 0
    s_cmp_eq_u64 s[0:1], 0
    s_cbranch_scc0 L_poll_28
L_polled_29:
    s_cmp_lg_u32 s3, 0
    s_cbranch_scc1 L_polled_31
    v_cmp_gt_u32 s[0:1], 2, v31
    s_mov_b32 s94, 0
    s_cmp_eq_u64 s[0:1], 0
    s_cbranch_scc1 L_polled_31
L_poll_30:
    s_add_u32 s94, s94, 1
    buffer_load_dword v31, v36, s[16:19], s15 offen sc1
    s_cmp_gt_u32 s94, 0x40000
    s_cbranch_scc1 L_polled_31
    s_waitcnt vmcnt(0)
    v_cmp_gt_u32 s[0:1], 2, v31
    s_nop 0
    s_cmp_eq_u64 s[0:1], 0
    s_cbranch_scc0 L_poll_30
L_polled_31:
    s_branch L_pkok_16
L_respec_18:
    v_accvgpr_read_b32 v4, a226
    s_mov_b32 s94, 0
L_respec_18_l:
    buffer_load_dword v5, v4, s[16:19], s15 offen sc1
    s_add_u32 s94, s94, 1
    s_cmp_gt_u32 s94, 0x40000
    s_cbranch_scc1 L_respec_18_d
    s_waitcnt vmcnt(0)
    v_cmp_gt_u32 s[0:1], 3, v5
    s_nop 0
    s_cmp_eq_u64 s[0:1], 0
    s_cbranch_scc0 L_respec_18_l
L_respec_18_d:
    s_xor_b32 s28, s43, 0
    buffer_load_dwordx4 a[0:3], v28, s[16:19], s28 offen sc1
    s_xor_b32 s28, s43, 4096
    buffer_load_dwordx4 a[4:7], v28, s[16:19], s28 offen sc1
    s_xor_b32 s28, s43, 16384
    buffer_load_dwordx4 a[8:11], v28, s[16:19], s28 offen sc1
    s_xor_b32 s28, s43, 20480
    buffer_load_dwordx4 a[12:15], v28, s[16:19], s28 offen sc1
    s_xor_b32 s28, s43, 32768
    buffer_load_dwordx4 a[16:19], v28, s[16:19], s28 offen sc1
    s_xor_b32 s28, s43, 36864
    buffer_load_dwordx4 a[20:23], v28, s[16:19], s28 offen sc1
    s_xor_b32 s28, s43, 49152
    buffer_load_dwordx4 a[24:27], v28, s[16:19], s28 offen sc1
    s_xor_b32 s28, s43, 53248
    buffer_load_dwordx4 a[28:31], v28, s[16:19], s28 offen sc1
    s_xor_b32 s28, s43, 65536
    buffer_load_dwordx4 a[32:35], v28, s[16:19], s28 offen sc1
    s_xor_b32 s28, s43, 69632
    buffer_load_dwordx4 a[36:39], v28, s[16:19], s28 offen sc1
    s_xor_b32 s28, s43, 81920
    buffer_load_dwordx4 a[40:43], v28, s[16:19], s28 offen sc1
    s_xor_b32 s28, s43, 86016
    buffer_load_dwordx4 a[44:47], v28, s[16:19], s28 offen sc1
    s_xor_b32 s28, s43, 98304
    buffer_load_dwordx4 a[48:51], v28, s[16:19], s28 offen sc1
    s_xor_b32 s28, s43, 102400
    buffer_load_dwordx4 a[52:55], v28, s[16:19], s28 offen sc1
    s_xor_b32 s28, s43, 114688
    buffer_load_dwordx4 a[56:59], v28, s[16:19], s28 offen sc1
    s_xor_b32 s28, s43, 118784
    buffer_load_dwordx4 a[60:63], v28, s[16:19], s28 offen sc1
    s_waitcnt vmcnt(15)
    v_mfma_f32_4x4x4_16b_bf16 v[128:131], a[224:225], a[0:1], 0
    v_mfma_f32_4x4x4_16b_bf16 v[132:135], a[224:225], a[2:3], 0
    s_waitcnt vmcnt(14)
    v_mfma_f32_4x4x4_16b_bf16 v[128:131], a[224:225], a[4:5], v[128:131]
    v_mfma_f32_4x4x4_16b_bf16 v[132:135], a[224:225], a[6:7], v[132:135]
    s_waitcnt vmcnt(13)
    v_mfma_f32_4x4x4_16b_bf16 v[128:131], a[224:225], a[8:9], v[128:131]
    v_mfma_f32_4x4x4_16b_bf16 v[132:135], a[224:225], a[10:11], v[132:135]
    s_waitcnt vmcnt(12)
    v_mfma_f32_4x4x4_16b_bf16 v[128:131], a[224:225], a[12:13], v[128:131]
    v_mfma_f32_4x4x4_16b_bf16 v[132:135], a[224:225], a[14:15], v[132:135]
    s_waitcnt vmcnt(11)
    v_mfma_f32_4x4x4_16b_bf16 v[128:131], a[224:225], a[16:17], v[128:131]
    v_mfma_f32_4x4x4_16b_bf16 v[132:135], a[224:225], a[18:19], v[132:135]
    s_waitcnt vmcnt(10)
    v_mfma_f32_4x4x4_16b_bf16 v[128:131], a[224:225], a[20:21], v[128:131]
    v_mfma_f32_4x4x4_16b_bf16 v[132:135], a[224:225], a[22:23], v[132:135]
    s_waitcnt vmcnt(9)
    v_mfma_f32_4x4x4_16b_bf16 v[128:131], a[224:225], a[24:25], v[128:131]
    v_mfma_f32_4x4x4_16b_bf16 v[132:135], a[224:225], a[26:27], v[132:135]
    s_waitcnt vmcnt(8)
    v_mfma_f32_4x4x4_16b_bf16 v[128:131], a[224:225], a[28:29], v[128:131]
    v_mfma_f32_4x4x4_16b_bf16 v[132:135], a[224:225], a[30:31], v[132:135]
    s_waitcnt vmcnt(7)
    v_mfma_f32_4x4x4_16b_bf16 v[128:131], a[224:225], a[32:33], v[128:131]
    v_mfma_f32_4x4x4_16b_bf16 v[132:135], a[224:225], a[34:35], v[132:135]
    s_waitcnt vmcnt(6)
    v_mfma_f32_4x4x4_16b_bf16 v[128:131], a[224:225], a[36:37], v[128:131]
    v_mfma_f32_4x4x4_16b_bf16 v[132:135], a[224:225], a[38:39], v[132:135]
    s_waitcnt vmcnt(5)
    v_mfma_f32_4x4x4_16b_bf16 v[128:131], a[224:225], a[40:41], v[128:131]
    v_mfma_f32_4x4x4_16b_bf16 v[132:135], a[224:225], a[42:43], v[132:135]
    s_waitcnt vmcnt(4)
    v_mfma_f32_4x4x4_16b_bf16 v[128:131], a[224:225], a[44:45], v[128:131]
    v_mfma_f32_4x4x4_16b_bf16 v[132:135], a[224:225], a[46:47], v[132:135]
    s_waitcnt vmcnt(3)
    v_mfma_f32_4x4x4_16b_bf16 v[128:131], a[224:225], a[48:49], v[128:131]
    v_mfma_f32_4x4x4_16b_bf16 v[132:135], a[224:225], a[50:51], v[132:135]
    s_waitcnt vmcnt(2)
    v_mfma_f32_4x4x4_16b_bf16 v[128:131], a[224:225], a[52:53], v[128:131]
    v_mfma_f32_4x4x4_16b_bf16 v[132:135], a[224:225], a[54:55], v[132:135]
    s_waitcnt vmcnt(1)
    v_mfma_f32_4x4x4_16b_bf16 v[128:131], a[224:225], a[56:57], v[128:131]
    v_mfma_f32_4x4x4_16b_bf16 v[132:135], a[224:225], a[58:59], v[132:135]
    s_waitcnt vmcnt(0)
    v_mfma_f32_4x4x4_16b_bf16 v[128:131], a[224:225], a[60:61], v[128:131]
    v_mfma_f32_4x4x4_16b_bf16 v[132:135], a[224:225], a[62:63], v[132:135]
    s_nop 11
    s_branch L_specok_19
L_last:
    s_endpgm
.section .rodata,"a"
.p2align 6
.amdhsa_kernel sequential_preLN__linear_kernel_hedgehog__dense_activation_squared_relu__prompt_kernel
  .amdhsa_next_free_vgpr 512
  .amdhsa_next_free_sgpr 102
  .amdhsa_accum_offset 256
  .amdhsa_group_segment_fixed_size 0
  .amdhsa_kernarg_size 96
  .amdhsa_user_sgpr_count 2
  .amdhsa_user_sgpr_kernarg_segment_ptr 1
  .amdhsa_system_sgpr_workgroup_id_x 1
.end_amdhsa_kernel
```
